```python
import torch

def _softmax(x, axis=-1):
    return torch.softmax(x, dim=axis)
def _gelu(x):
    return torch.nn.functional.gelu(x, approximate="tanh")
def _silu(x):
    return torch.nn.functional.silu(x)
def _sigmoid(x):
    return torch.sigmoid(x)
def _layernorm(x, axis=-1, eps=1e-5):
    m = x.mean(dim=axis, keepdim=True)
    v = x.var(dim=axis, keepdim=True, unbiased=False)
    return (x - m) / torch.sqrt(v + eps)
def _scatter_add(tgt, idx, src, axis=0):
    return tgt.clone().index_add_(axis, idx, src)
def _segment_sum(src, seg, n):
    out = torch.zeros((n,) + src.shape[1:], dtype=src.dtype)
    return out.index_add_(0, seg, src)
def _pad(x, pw):
    flat = tuple(v for pair in reversed(pw) for v in pair)
    return torch.nn.functional.pad(x, flat)

kernel_name = 'recurrent_scan__ssm_conv_s4__dense_activation_mish__prompt'

def setup_inputs():

    _w = (lambda a: (lambda t: t.to(torch.bfloat16) if t.is_floating_point() else t)(torch.as_tensor(a)))
    def _A_setup():
        B, L, D, N = 1, 2048, 640, 128
        A_re = -(lambda _x: torch.exp(torch.as_tensor(_x)))((lambda *s: torch.randn(*s, dtype=torch.bfloat16) * 3.2)(D, N))
        A_im = torch.pi * (lambda *s: torch.randn(*s, dtype=torch.bfloat16) * 0.2)(D, N)
        B_re = (lambda *s: torch.randn(*s, dtype=torch.bfloat16) * 0.2)(D, N)
        B_im = (lambda *s: torch.randn(*s, dtype=torch.bfloat16) * 0.2)(D, N)
        C_re = (lambda *s: torch.randn(*s, dtype=torch.bfloat16) * 0.2)(D, N)
        C_im = (lambda *s: torch.randn(*s, dtype=torch.bfloat16) * 0.2)(D, N)
        log_dt = (lambda *s: torch.randn(*s, dtype=torch.bfloat16) * 0.2)(D) * 0.5 - 4.0
        Dskip = (lambda *s: torch.randn(*s, dtype=torch.bfloat16) * 0.2)(D)
        return {
            "u": _w((lambda *s: torch.randn(*s, dtype=torch.bfloat16) * 0.05)(B, L, D)),
            "A_re": _w(A_re),
            "A_im": _w(A_im),
            "B_re": _w(B_re),
            "B_im": _w(B_im),
            "C_re": _w(C_re),
            "C_im": _w(C_im),
            "log_dt": _w(log_dt),
            "Dskip": _w(Dskip),
        }
    _A_in = _A_setup()

    def _B_setup():
        B, S, D, F = 1, 2048, 640, 1728
        return {
            "x": _w((lambda *s: torch.randn(*s, dtype=torch.bfloat16) * 0.05)(B, S, D)),
            "w1": _w((lambda *s: torch.randn(*s, dtype=torch.bfloat16) * 0.8)(D, F) * (D ** -0.5)),
            "b1": _w((lambda *s: torch.randn(*s, dtype=torch.bfloat16) * 0.4)(F)),
            "w2": _w((lambda *s: torch.randn(*s, dtype=torch.bfloat16) * 0.1)(F, D) * (F ** -0.5)),
        }
    _B_in = _B_setup()

    return {
        "A_u": _A_in["u"],
        "A_A_re": _A_in["A_re"],
        "A_A_im": _A_in["A_im"],
        "A_B_re": _A_in["B_re"],
        "A_B_im": _A_in["B_im"],
        "A_C_re": _A_in["C_re"],
        "A_C_im": _A_in["C_im"],
        "A_log_dt": _A_in["log_dt"],
        "A_Dskip": _A_in["Dskip"],
        "B_x": _B_in["x"],
        "B_w1": _B_in["w1"],
        "B_b1": _B_in["b1"],
        "B_w2": _B_in["w2"],
    }

def reference(A_u, A_A_re, A_A_im, A_B_re, A_B_im, A_C_re, A_C_im, A_log_dt, A_Dskip, B_x, B_w1, B_b1, B_w2):
    def _A_ref(u, A_re, A_im, B_re, B_im, C_re, C_im, log_dt, Dskip):
        Bsz, L, D = u.shape
        dt = torch.exp(log_dt)[:, None]
        A = A_re + 1j * A_im
        Bc = B_re + 1j * B_im
        Cc = C_re + 1j * C_im
        logdA = dt * A
        dB = dt * Bc
        l = (lambda x, dt: x.to(dt))(torch.arange(L), A_re.dtype)
        P = torch.exp(logdA[:, :, None] * l[None, None, :])
        K = torch.einsum("dn,dnl,dn->dl", Cc, P, dB).real
        L2 = 2 * L
        Kp = _pad(K, ((0, 0), (0, L)))
        up = (lambda x, *d: x.permute(*d))(u, 0, 2, 1)
        up = _pad(up, ((0, 0), (0, 0), (0, L)))
        Kf = (lambda x, axes=(-2,-1): torch.fft.rfft2(x.float(), dim=axes))(Kp[:, None, :], axes=(-2, -1))
        Uf = (lambda x, axes=(-2,-1): torch.fft.rfft2(x.float(), dim=axes))(up[:, :, None, :], axes=(-2, -1))
        Yf = Uf * Kf[None, :, :, :]
        y = (lambda x, s, axes=(-2,-1): torch.fft.irfft2(x, s=s, dim=axes).to(torch.bfloat16))(Yf, (1, L2), axes=(-2, -1))[:, :, 0, :L]
        y = (lambda x, *d: x.permute(*d))(y, 0, 2, 1) + u * Dskip[None, None, :]
        return y

    def _B_ref(x, w1, b1, w2):
        h = torch.einsum("bsd,df->bsf", x, w1) + b1
        sp = torch.log1p(torch.exp(-torch.abs(h))) + torch.where(h > 0, h, torch.zeros_like(h))
        act = h * torch.tanh(sp)
        return torch.einsum("bsf,fd->bsd", act, w2)

    x = A_u
    xn = _layernorm(x, axis=-1)
    s = _A_ref(xn, A_A_re, A_A_im, A_B_re, A_B_im, A_C_re, A_C_im, A_log_dt, A_Dskip)
    g = _silu(_B_ref(xn, B_w1, B_b1, B_w2))
    return x + s * g
```

```asm
; @launch kernel=k1_kernel grid=(502,1,1) block=(512,1,1) lds=81920
; @launch kernel=k2_kernel grid=(512,1,1) block=(256,1,1) lds=81920
.amdgcn_target "amdgcn-amd-amdhsa--gfx950"
.text
.globl k1_kernel
.p2align 8
.type k1_kernel,@function
k1_kernel:
  s_cmp_lt_u32 s2, 224
  s_cbranch_scc1 L_g1
  s_sub_u32 s2, s2, 224
  s_cmp_lt_u32 s2, 160
  s_cbranch_scc1 L_kg
  s_sub_u32 s2, s2, 160
  s_cmp_lt_u32 s2, 64
  s_cbranch_scc1 L_ln
  s_sub_u32 s2, s2, 64
  s_cmp_lt_u32 s2, 54
  s_cbranch_scc1 L_w2
  s_sub_u32 s2, s2, 54
  s_endpgm
L_ln:
  s_setprio 2
  s_load_dwordx2 s[4:5], s[0:1], 0
  s_load_dwordx2 s[6:7], s[0:1], 120
  s_load_dwordx2 s[16:17], s[0:1], 112
  s_and_b32 s3, s2, 3
  s_lshl_b32 s3, s3, 4
  s_and_b32 s21, s2, 4
  s_lshl_b32 s21, s21, 1
  s_lshr_b32 s2, s2, 3
  s_add_u32 s2, s2, s3
  s_add_u32 s2, s2, s21
  v_lshrrev_b32 v1, 4, v0
  v_and_b32 v2, 15, v0
  v_mul_u32_u24 v3, 1280, v1
  v_lshl_add_u32 v3, v2, 4, v3
  s_mul_i32 s3, s2, 40960
  s_mov_b32 s20, 0x3f803f80
  s_waitcnt lgkmcnt(0)
  s_mov_b32 s8, s4
  s_mov_b32 s9, s5
  s_mov_b32 s10, 2621440
  s_mov_b32 s11, 0x00020000
  s_add_u32 s12, s6, 10485760
  s_addc_u32 s13, s7, 0
  s_mov_b32 s14, 2621440
  s_mov_b32 s15, 0x00020000
  buffer_load_dwordx4 v[10:13], v3, s[8:11], s3 offen offset:0
  buffer_load_dwordx4 v[14:17], v3, s[8:11], s3 offen offset:256
  buffer_load_dwordx4 v[18:21], v3, s[8:11], s3 offen offset:512
  buffer_load_dwordx4 v[22:25], v3, s[8:11], s3 offen offset:768
  buffer_load_dwordx4 v[26:29], v3, s[8:11], s3 offen offset:1024
  v_mov_b32 v4, 0
  v_mov_b32 v5, 0
  v_mul_u32_u24 v6, 1312, v1
  v_lshl_add_u32 v6, v2, 4, v6
  s_waitcnt vmcnt(4)
  v_lshlrev_b32 v32, 16, v10
  v_and_b32 v33, 0xffff0000, v10
  v_add_f32 v4, v4, v32
  v_fmac_f32 v5, v32, v32
  v_add_f32 v4, v4, v33
  v_fmac_f32 v5, v33, v33
  v_lshlrev_b32 v34, 16, v11
  v_and_b32 v35, 0xffff0000, v11
  v_add_f32 v4, v4, v34
  v_fmac_f32 v5, v34, v34
  v_add_f32 v4, v4, v35
  v_fmac_f32 v5, v35, v35
  v_lshlrev_b32 v36, 16, v12
  v_and_b32 v37, 0xffff0000, v12
  v_add_f32 v4, v4, v36
  v_fmac_f32 v5, v36, v36
  v_add_f32 v4, v4, v37
  v_fmac_f32 v5, v37, v37
  v_lshlrev_b32 v38, 16, v13
  v_and_b32 v39, 0xffff0000, v13
  v_add_f32 v4, v4, v38
  v_fmac_f32 v5, v38, v38
  v_add_f32 v4, v4, v39
  v_fmac_f32 v5, v39, v39
  s_waitcnt vmcnt(3)
  v_lshlrev_b32 v40, 16, v14
  v_and_b32 v41, 0xffff0000, v14
  v_add_f32 v4, v4, v40
  v_fmac_f32 v5, v40, v40
  v_add_f32 v4, v4, v41
  v_fmac_f32 v5, v41, v41
  v_lshlrev_b32 v42, 16, v15
  v_and_b32 v43, 0xffff0000, v15
  v_add_f32 v4, v4, v42
  v_fmac_f32 v5, v42, v42
  v_add_f32 v4, v4, v43
  v_fmac_f32 v5, v43, v43
  v_lshlrev_b32 v44, 16, v16
  v_and_b32 v45, 0xffff0000, v16
  v_add_f32 v4, v4, v44
  v_fmac_f32 v5, v44, v44
  v_add_f32 v4, v4, v45
  v_fmac_f32 v5, v45, v45
  v_lshlrev_b32 v46, 16, v17
  v_and_b32 v47, 0xffff0000, v17
  v_add_f32 v4, v4, v46
  v_fmac_f32 v5, v46, v46
  v_add_f32 v4, v4, v47
  v_fmac_f32 v5, v47, v47
  s_waitcnt vmcnt(2)
  v_lshlrev_b32 v48, 16, v18
  v_and_b32 v49, 0xffff0000, v18
  v_add_f32 v4, v4, v48
  v_fmac_f32 v5, v48, v48
  v_add_f32 v4, v4, v49
  v_fmac_f32 v5, v49, v49
  v_lshlrev_b32 v50, 16, v19
  v_and_b32 v51, 0xffff0000, v19
  v_add_f32 v4, v4, v50
  v_fmac_f32 v5, v50, v50
  v_add_f32 v4, v4, v51
  v_fmac_f32 v5, v51, v51
  v_lshlrev_b32 v52, 16, v20
  v_and_b32 v53, 0xffff0000, v20
  v_add_f32 v4, v4, v52
  v_fmac_f32 v5, v52, v52
  v_add_f32 v4, v4, v53
  v_fmac_f32 v5, v53, v53
  v_lshlrev_b32 v54, 16, v21
  v_and_b32 v55, 0xffff0000, v21
  v_add_f32 v4, v4, v54
  v_fmac_f32 v5, v54, v54
  v_add_f32 v4, v4, v55
  v_fmac_f32 v5, v55, v55
  s_waitcnt vmcnt(1)
  v_lshlrev_b32 v56, 16, v22
  v_and_b32 v57, 0xffff0000, v22
  v_add_f32 v4, v4, v56
  v_fmac_f32 v5, v56, v56
  v_add_f32 v4, v4, v57
  v_fmac_f32 v5, v57, v57
  v_lshlrev_b32 v58, 16, v23
  v_and_b32 v59, 0xffff0000, v23
  v_add_f32 v4, v4, v58
  v_fmac_f32 v5, v58, v58
  v_add_f32 v4, v4, v59
  v_fmac_f32 v5, v59, v59
  v_lshlrev_b32 v60, 16, v24
  v_and_b32 v61, 0xffff0000, v24
  v_add_f32 v4, v4, v60
  v_fmac_f32 v5, v60, v60
  v_add_f32 v4, v4, v61
  v_fmac_f32 v5, v61, v61
  v_lshlrev_b32 v62, 16, v25
  v_and_b32 v63, 0xffff0000, v25
  v_add_f32 v4, v4, v62
  v_fmac_f32 v5, v62, v62
  v_add_f32 v4, v4, v63
  v_fmac_f32 v5, v63, v63
  s_waitcnt vmcnt(0)
  v_lshlrev_b32 v64, 16, v26
  v_and_b32 v65, 0xffff0000, v26
  v_add_f32 v4, v4, v64
  v_fmac_f32 v5, v64, v64
  v_add_f32 v4, v4, v65
  v_fmac_f32 v5, v65, v65
  v_lshlrev_b32 v66, 16, v27
  v_and_b32 v67, 0xffff0000, v27
  v_add_f32 v4, v4, v66
  v_fmac_f32 v5, v66, v66
  v_add_f32 v4, v4, v67
  v_fmac_f32 v5, v67, v67
  v_lshlrev_b32 v68, 16, v28
  v_and_b32 v69, 0xffff0000, v28
  v_add_f32 v4, v4, v68
  v_fmac_f32 v5, v68, v68
  v_add_f32 v4, v4, v69
  v_fmac_f32 v5, v69, v69
  v_lshlrev_b32 v70, 16, v29
  v_and_b32 v71, 0xffff0000, v29
  v_add_f32 v4, v4, v70
  v_fmac_f32 v5, v70, v70
  v_add_f32 v4, v4, v71
  v_fmac_f32 v5, v71, v71
  s_nop 0
  v_add_f32_dpp v4, v4, v4 quad_perm:[1,0,3,2] row_mask:0xf bank_mask:0xf
  v_add_f32_dpp v5, v5, v5 quad_perm:[1,0,3,2] row_mask:0xf bank_mask:0xf
  s_nop 0
  v_add_f32_dpp v4, v4, v4 quad_perm:[2,3,0,1] row_mask:0xf bank_mask:0xf
  v_add_f32_dpp v5, v5, v5 quad_perm:[2,3,0,1] row_mask:0xf bank_mask:0xf
  s_nop 0
  v_add_f32_dpp v4, v4, v4 row_half_mirror row_mask:0xf bank_mask:0xf
  v_add_f32_dpp v5, v5, v5 row_half_mirror row_mask:0xf bank_mask:0xf
  s_nop 0
  v_add_f32_dpp v4, v4, v4 row_mirror row_mask:0xf bank_mask:0xf
  v_add_f32_dpp v5, v5, v5 row_mirror row_mask:0xf bank_mask:0xf
  v_mul_f32 v4, 0x3acccccd, v4
  v_mul_f32 v5, 0x3acccccd, v5
  v_fma_f32 v5, -v4, v4, v5
  v_max_f32 v5, 0, v5
  v_cvt_pk_bf16_f32 v7, v4, v5
  v_lshlrev_b32 v4, 16, v7
  v_and_b32 v8, 0xffff0000, v7
  v_add_f32 v8, 0x3727c5ac, v8
  v_cvt_pk_bf16_f32 v8, v8, v8
  v_lshlrev_b32 v8, 16, v8
  v_sqrt_f32 v8, v8
  s_nop 0
  v_cvt_pk_bf16_f32 v8, v8, v8
  v_lshlrev_b32 v8, 16, v8
  v_rcp_f32 v5, v8
  s_add_u32 s28, s6, 22020096
  s_addc_u32 s29, s7, 0
  s_mov_b32 s30, 16384
  s_mov_b32 s31, 0x00020000
  s_mov_b32 s32, s16
  s_mov_b32 s33, s17
  s_mov_b32 s34, 256
  s_mov_b32 s35, 0x00020000
  v_mul_f32 v79, 0x3fb8aa3b, v5
  v_mul_f32 v78, v4, v79
  v_sub_f32 v78, 0, v78
  v_lshlrev_b32 v77, 3, v1
  v_lshl_add_u32 v77, v2, 16, v77
  s_lshl_b32 s21, s2, 8
  buffer_store_dwordx2 v[78:79], v77, s[28:31], s21 offen sc1
  v_sub_f32 v32, v32, v4
  v_sub_f32 v33, v33, v4
  v_sub_f32 v34, v34, v4
  v_sub_f32 v35, v35, v4
  v_sub_f32 v36, v36, v4
  v_sub_f32 v37, v37, v4
  v_sub_f32 v38, v38, v4
  v_sub_f32 v39, v39, v4
  v_sub_f32 v40, v40, v4
  v_sub_f32 v41, v41, v4
  v_sub_f32 v42, v42, v4
  v_sub_f32 v43, v43, v4
  v_sub_f32 v44, v44, v4
  v_sub_f32 v45, v45, v4
  v_sub_f32 v46, v46, v4
  v_sub_f32 v47, v47, v4
  v_sub_f32 v48, v48, v4
  v_sub_f32 v49, v49, v4
  v_sub_f32 v50, v50, v4
  v_sub_f32 v51, v51, v4
  v_sub_f32 v52, v52, v4
  v_sub_f32 v53, v53, v4
  v_sub_f32 v54, v54, v4
  v_sub_f32 v55, v55, v4
  v_sub_f32 v56, v56, v4
  v_sub_f32 v57, v57, v4
  v_sub_f32 v58, v58, v4
  v_sub_f32 v59, v59, v4
  v_sub_f32 v60, v60, v4
  v_sub_f32 v61, v61, v4
  v_sub_f32 v62, v62, v4
  v_sub_f32 v63, v63, v4
  v_sub_f32 v64, v64, v4
  v_sub_f32 v65, v65, v4
  v_sub_f32 v66, v66, v4
  v_sub_f32 v67, v67, v4
  v_sub_f32 v68, v68, v4
  v_sub_f32 v69, v69, v4
  v_sub_f32 v70, v70, v4
  v_sub_f32 v71, v71, v4
  v_cvt_pk_bf16_f32 v10, v32, v33
  v_cvt_pk_bf16_f32 v11, v34, v35
  v_cvt_pk_bf16_f32 v12, v36, v37
  v_cvt_pk_bf16_f32 v13, v38, v39
  v_cvt_pk_bf16_f32 v14, v40, v41
  v_cvt_pk_bf16_f32 v15, v42, v43
  v_cvt_pk_bf16_f32 v16, v44, v45
  v_cvt_pk_bf16_f32 v17, v46, v47
  v_cvt_pk_bf16_f32 v18, v48, v49
  v_cvt_pk_bf16_f32 v19, v50, v51
  v_cvt_pk_bf16_f32 v20, v52, v53
  v_cvt_pk_bf16_f32 v21, v54, v55
  v_cvt_pk_bf16_f32 v22, v56, v57
  v_cvt_pk_bf16_f32 v23, v58, v59
  v_cvt_pk_bf16_f32 v24, v60, v61
  v_cvt_pk_bf16_f32 v25, v62, v63
  v_cvt_pk_bf16_f32 v26, v64, v65
  v_cvt_pk_bf16_f32 v27, v66, v67
  v_cvt_pk_bf16_f32 v28, v68, v69
  v_cvt_pk_bf16_f32 v29, v70, v71
  v_lshlrev_b32 v32, 16, v10
  v_and_b32 v33, 0xffff0000, v10
  v_lshlrev_b32 v34, 16, v11
  v_and_b32 v35, 0xffff0000, v11
  v_lshlrev_b32 v36, 16, v12
  v_and_b32 v37, 0xffff0000, v12
  v_lshlrev_b32 v38, 16, v13
  v_and_b32 v39, 0xffff0000, v13
  v_lshlrev_b32 v40, 16, v14
  v_and_b32 v41, 0xffff0000, v14
  v_lshlrev_b32 v42, 16, v15
  v_and_b32 v43, 0xffff0000, v15
  v_lshlrev_b32 v44, 16, v16
  v_and_b32 v45, 0xffff0000, v16
  v_lshlrev_b32 v46, 16, v17
  v_and_b32 v47, 0xffff0000, v17
  v_lshlrev_b32 v48, 16, v18
  v_and_b32 v49, 0xffff0000, v18
  v_lshlrev_b32 v50, 16, v19
  v_and_b32 v51, 0xffff0000, v19
  v_lshlrev_b32 v52, 16, v20
  v_and_b32 v53, 0xffff0000, v20
  v_lshlrev_b32 v54, 16, v21
  v_and_b32 v55, 0xffff0000, v21
  v_lshlrev_b32 v56, 16, v22
  v_and_b32 v57, 0xffff0000, v22
  v_lshlrev_b32 v58, 16, v23
  v_and_b32 v59, 0xffff0000, v23
  v_lshlrev_b32 v60, 16, v24
  v_and_b32 v61, 0xffff0000, v24
  v_lshlrev_b32 v62, 16, v25
  v_and_b32 v63, 0xffff0000, v25
  v_lshlrev_b32 v64, 16, v26
  v_and_b32 v65, 0xffff0000, v26
  v_lshlrev_b32 v66, 16, v27
  v_and_b32 v67, 0xffff0000, v27
  v_lshlrev_b32 v68, 16, v28
  v_and_b32 v69, 0xffff0000, v28
  v_lshlrev_b32 v70, 16, v29
  v_and_b32 v71, 0xffff0000, v29
  v_mul_f32 v32, v32, v5
  v_mul_f32 v33, v33, v5
  v_mul_f32 v34, v34, v5
  v_mul_f32 v35, v35, v5
  v_mul_f32 v36, v36, v5
  v_mul_f32 v37, v37, v5
  v_mul_f32 v38, v38, v5
  v_mul_f32 v39, v39, v5
  v_mul_f32 v40, v40, v5
  v_mul_f32 v41, v41, v5
  v_mul_f32 v42, v42, v5
  v_mul_f32 v43, v43, v5
  v_mul_f32 v44, v44, v5
  v_mul_f32 v45, v45, v5
  v_mul_f32 v46, v46, v5
  v_mul_f32 v47, v47, v5
  v_mul_f32 v48, v48, v5
  v_mul_f32 v49, v49, v5
  v_mul_f32 v50, v50, v5
  v_mul_f32 v51, v51, v5
  v_mul_f32 v52, v52, v5
  v_mul_f32 v53, v53, v5
  v_mul_f32 v54, v54, v5
  v_mul_f32 v55, v55, v5
  v_mul_f32 v56, v56, v5
  v_mul_f32 v57, v57, v5
  v_mul_f32 v58, v58, v5
  v_mul_f32 v59, v59, v5
  v_mul_f32 v60, v60, v5
  v_mul_f32 v61, v61, v5
  v_mul_f32 v62, v62, v5
  v_mul_f32 v63, v63, v5
  v_mul_f32 v64, v64, v5
  v_mul_f32 v65, v65, v5
  v_mul_f32 v66, v66, v5
  v_mul_f32 v67, v67, v5
  v_mul_f32 v68, v68, v5
  v_mul_f32 v69, v69, v5
  v_mul_f32 v70, v70, v5
  v_mul_f32 v71, v71, v5
  v_cvt_pk_bf16_f32 v10, v32, v33
  v_cvt_pk_bf16_f32 v11, v34, v35
  v_cvt_pk_bf16_f32 v12, v36, v37
  v_cvt_pk_bf16_f32 v13, v38, v39
  v_cvt_pk_bf16_f32 v14, v40, v41
  v_cvt_pk_bf16_f32 v15, v42, v43
  v_cvt_pk_bf16_f32 v16, v44, v45
  v_cvt_pk_bf16_f32 v17, v46, v47
  v_cvt_pk_bf16_f32 v18, v48, v49
  v_cvt_pk_bf16_f32 v19, v50, v51
  v_cvt_pk_bf16_f32 v20, v52, v53
  v_cvt_pk_bf16_f32 v21, v54, v55
  v_cvt_pk_bf16_f32 v22, v56, v57
  v_cvt_pk_bf16_f32 v23, v58, v59
  v_cvt_pk_bf16_f32 v24, v60, v61
  v_cvt_pk_bf16_f32 v25, v62, v63
  v_cvt_pk_bf16_f32 v26, v64, v65
  v_cvt_pk_bf16_f32 v27, v66, v67
  v_cvt_pk_bf16_f32 v28, v68, v69
  v_cvt_pk_bf16_f32 v29, v70, v71
  v_lshlrev_b32 v32, 16, v10
  v_and_b32 v33, 0xffff0000, v10
  v_lshlrev_b32 v34, 16, v11
  v_and_b32 v35, 0xffff0000, v11
  v_lshlrev_b32 v36, 16, v12
  v_and_b32 v37, 0xffff0000, v12
  v_lshlrev_b32 v38, 16, v13
  v_and_b32 v39, 0xffff0000, v13
  v_lshlrev_b32 v40, 16, v14
  v_and_b32 v41, 0xffff0000, v14
  v_lshlrev_b32 v42, 16, v15
  v_and_b32 v43, 0xffff0000, v15
  v_lshlrev_b32 v44, 16, v16
  v_and_b32 v45, 0xffff0000, v16
  v_lshlrev_b32 v46, 16, v17
  v_and_b32 v47, 0xffff0000, v17
  v_lshlrev_b32 v48, 16, v18
  v_and_b32 v49, 0xffff0000, v18
  v_lshlrev_b32 v50, 16, v19
  v_and_b32 v51, 0xffff0000, v19
  v_lshlrev_b32 v52, 16, v20
  v_and_b32 v53, 0xffff0000, v20
  v_lshlrev_b32 v54, 16, v21
  v_and_b32 v55, 0xffff0000, v21
  v_lshlrev_b32 v56, 16, v22
  v_and_b32 v57, 0xffff0000, v22
  v_lshlrev_b32 v58, 16, v23
  v_and_b32 v59, 0xffff0000, v23
  v_lshlrev_b32 v60, 16, v24
  v_and_b32 v61, 0xffff0000, v24
  v_lshlrev_b32 v62, 16, v25
  v_and_b32 v63, 0xffff0000, v25
  v_lshlrev_b32 v64, 16, v26
  v_and_b32 v65, 0xffff0000, v26
  v_lshlrev_b32 v66, 16, v27
  v_and_b32 v67, 0xffff0000, v27
  v_lshlrev_b32 v68, 16, v28
  v_and_b32 v69, 0xffff0000, v28
  v_lshlrev_b32 v70, 16, v29
  v_and_b32 v71, 0xffff0000, v29
  v_cvt_pk_f16_f32 v10, v32, v33
  v_cvt_pk_f16_f32 v11, v34, v35
  v_cvt_pk_f16_f32 v12, v36, v37
  v_cvt_pk_f16_f32 v13, v38, v39
  ds_write_b128 v6, v[10:13] offset:0
  v_cvt_pk_f16_f32 v14, v40, v41
  v_cvt_pk_f16_f32 v15, v42, v43
  v_cvt_pk_f16_f32 v16, v44, v45
  v_cvt_pk_f16_f32 v17, v46, v47
  ds_write_b128 v6, v[14:17] offset:256
  v_cvt_pk_f16_f32 v18, v48, v49
  v_cvt_pk_f16_f32 v19, v50, v51
  v_cvt_pk_f16_f32 v20, v52, v53
  v_cvt_pk_f16_f32 v21, v54, v55
  ds_write_b128 v6, v[18:21] offset:512
  v_cvt_pk_f16_f32 v22, v56, v57
  v_cvt_pk_f16_f32 v23, v58, v59
  v_cvt_pk_f16_f32 v24, v60, v61
  v_cvt_pk_f16_f32 v25, v62, v63
  ds_write_b128 v6, v[22:25] offset:768
  v_cvt_pk_f16_f32 v26, v64, v65
  v_cvt_pk_f16_f32 v27, v66, v67
  v_cvt_pk_f16_f32 v28, v68, v69
  v_cvt_pk_f16_f32 v29, v70, v71
  ds_write_b128 v6, v[26:29] offset:1024
  v_and_b32 v1, 63, v0
  v_lshrrev_b32 v2, 6, v0
  v_and_b32 v3, 15, v1
  v_lshrrev_b32 v4, 4, v1
  v_lshrrev_b32 v5, 2, v3
  v_lshl_add_u32 v5, v4, 2, v5
  v_mul_u32_u24 v5, 1312, v5
  v_and_b32 v7, 3, v3
  v_lshl_add_u32 v5, v7, 3, v5
  v_mul_u32_u24 v7, 160, v2
  v_add_u32 v5, v5, v7
  v_mov_b32 v78, 1
  v_lshlrev_b32 v77, 10, v0
  s_lshl_b32 s21, s2, 2
  s_waitcnt vmcnt(0)
  s_waitcnt lgkmcnt(0)
  s_barrier
  buffer_store_dword v78, v77, s[32:35], s21 offen sc1
  ds_read_b64_tr_b16 v[10:11], v5 offset:0
  ds_read_b64_tr_b16 v[12:13], v5 offset:20992
  ds_read_b64_tr_b16 v[14:15], v5 offset:32
  ds_read_b64_tr_b16 v[16:17], v5 offset:21024
  ds_read_b64_tr_b16 v[18:19], v5 offset:64
  ds_read_b64_tr_b16 v[20:21], v5 offset:21056
  ds_read_b64_tr_b16 v[22:23], v5 offset:96
  ds_read_b64_tr_b16 v[24:25], v5 offset:21088
  ds_read_b64_tr_b16 v[26:27], v5 offset:128
  ds_read_b64_tr_b16 v[28:29], v5 offset:21120
  v_mul_u32_u24 v7, 5120, v2
  v_lshl_add_u32 v8, v3, 6, v7
  v_lshrrev_b32 v9, 1, v3
  v_and_b32 v9, 3, v9
  v_lshrrev_b32 v52, 1, v4
  v_xor_b32 v9, v9, v52
  v_lshl_add_u32 v8, v9, 4, v8
  v_and_b32 v9, 1, v4
  v_lshl_add_u32 v8, v9, 3, v8
  v_xor_b32 v9, 32, v8
  v_lshrrev_b32 v52, 2, v1
  v_lshl_add_u32 v52, v52, 6, v7
  v_lshrrev_b32 v53, 3, v1
  v_xor_b32 v53, v53, v1
  v_and_b32 v53, 3, v53
  v_lshl_add_u32 v52, v53, 4, v52
  v_lshl_add_u32 v53, v1, 4, v7
  s_waitcnt lgkmcnt(0)
  s_barrier
  ds_write_b64 v8, v[10:11] offset:0
  ds_write_b64 v9, v[12:13] offset:0
  ds_write_b64 v8, v[14:15] offset:1024
  ds_write_b64 v9, v[16:17] offset:1024
  ds_write_b64 v8, v[18:19] offset:2048
  ds_write_b64 v9, v[20:21] offset:2048
  ds_write_b64 v8, v[22:23] offset:3072
  ds_write_b64 v9, v[24:25] offset:3072
  ds_write_b64 v8, v[26:27] offset:4096
  ds_write_b64 v9, v[28:29] offset:4096
  ds_read_b128 v[10:13], v52 offset:0
  ds_read_b128 v[14:17], v52 offset:1024
  ds_read_b128 v[18:21], v52 offset:2048
  ds_read_b128 v[22:25], v52 offset:3072
  ds_read_b128 v[26:29], v52 offset:4096
  s_waitcnt lgkmcnt(4)
  buffer_store_dwordx4 v[10:13], v53, s[12:15], s3 offen offset:0 sc1
  s_waitcnt lgkmcnt(3)
  buffer_store_dwordx4 v[14:17], v53, s[12:15], s3 offen offset:1024 sc1
  s_waitcnt lgkmcnt(2)
  buffer_store_dwordx4 v[18:21], v53, s[12:15], s3 offen offset:2048 sc1
  s_waitcnt lgkmcnt(1)
  buffer_store_dwordx4 v[22:25], v53, s[12:15], s3 offen offset:3072 sc1
  s_waitcnt lgkmcnt(0)
  s_add_u32 s3, s3, 4096
  buffer_store_dwordx4 v[26:29], v53, s[12:15], s3 offen offset:0 sc1
  s_setprio 0
  s_add_u32 s24, s6, 17825792
  s_addc_u32 s25, s7, 0
  s_mov_b32 s26, 2621440
  s_mov_b32 s27, 0x00020000
  v_mov_b32 v72, -1
  v_mov_b32 v73, -1
  v_mov_b32 v74, -1
  v_mov_b32 v75, -1
  v_lshlrev_b32 v76, 4, v0
  s_mul_i32 s3, s2, 40960
  s_add_u32 s21, s3, 0
  buffer_store_dwordx4 v[72:75], v76, s[24:27], s21 offen sc1
  s_add_u32 s21, s3, 8192
  buffer_store_dwordx4 v[72:75], v76, s[24:27], s21 offen sc1
  s_add_u32 s21, s3, 16384
  buffer_store_dwordx4 v[72:75], v76, s[24:27], s21 offen sc1
  s_add_u32 s21, s3, 24576
  buffer_store_dwordx4 v[72:75], v76, s[24:27], s21 offen sc1
  s_add_u32 s21, s3, 32768
  buffer_store_dwordx4 v[72:75], v76, s[24:27], s21 offen sc1
  s_endpgm
L_w2:
  s_load_dwordx2 s[4:5], s[0:1], 96
  s_load_dwordx2 s[6:7], s[0:1], 120
  v_and_b32 v1, 63, v0
  v_lshrrev_b32 v2, 6, v0
  s_nop 0
  v_readfirstlane_b32 s16, v2
  v_lshlrev_b32 v7, 4, v1
  s_mul_i32 s3, s2, 40960
  s_mul_i32 s18, s16, 5120
  s_add_u32 s3, s3, s18
  s_waitcnt lgkmcnt(0)
  s_mov_b32 s8, s4
  s_mov_b32 s9, s5
  s_mov_b32 s10, 2211840
  s_mov_b32 s11, 0x00020000
  s_add_u32 s12, s6, 7340032
  s_addc_u32 s13, s7, 0
  s_mov_b32 s14, 2211840
  s_mov_b32 s15, 0x00020000
  s_add_u32 m0, s18, 0
  s_add_u32 s19, s3, 0
  buffer_load_dwordx4 v7, s[8:11], s19 offen lds
  s_add_u32 m0, s18, 1024
  s_add_u32 s19, s3, 1024
  buffer_load_dwordx4 v7, s[8:11], s19 offen lds
  s_add_u32 m0, s18, 2048
  s_add_u32 s19, s3, 2048
  buffer_load_dwordx4 v7, s[8:11], s19 offen lds
  s_add_u32 m0, s18, 3072
  s_add_u32 s19, s3, 3072
  buffer_load_dwordx4 v7, s[8:11], s19 offen lds
  s_add_u32 m0, s18, 4096
  s_add_u32 s19, s3, 4096
  buffer_load_dwordx4 v7, s[8:11], s19 offen lds
  v_and_b32 v3, 15, v1
  v_lshrrev_b32 v4, 4, v1
  v_lshrrev_b32 v5, 2, v3
  v_lshrrev_b32 v6, 1, v4
  v_lshl_add_u32 v5, v6, 4, v5
  v_and_b32 v6, 1, v4
  v_lshl_add_u32 v5, v6, 2, v5
  v_mul_u32_u24 v5, 1280, v5
  v_and_b32 v6, 3, v3
  v_lshl_add_u32 v5, v6, 3, v5
  v_mul_u32_u24 v6, 160, v2
  v_add_u32 v5, v5, v6
  s_mul_i32 s17, s16, 270
  s_add_u32 s17, s17, s2
  s_lshl_b32 s17, s17, 10
  s_waitcnt vmcnt(0)
  s_barrier
  ds_read_b64_tr_b16 v[10:11], v5 offset:0
  ds_read_b64_tr_b16 v[12:13], v5 offset:10240
  ds_read_b64_tr_b16 v[14:15], v5 offset:32
  ds_read_b64_tr_b16 v[16:17], v5 offset:10272
  ds_read_b64_tr_b16 v[18:19], v5 offset:64
  ds_read_b64_tr_b16 v[20:21], v5 offset:10304
  ds_read_b64_tr_b16 v[22:23], v5 offset:96
  ds_read_b64_tr_b16 v[24:25], v5 offset:10336
  ds_read_b64_tr_b16 v[26:27], v5 offset:128
  ds_read_b64_tr_b16 v[28:29], v5 offset:10368
  s_waitcnt lgkmcnt(8)
  buffer_store_dwordx4 v[10:13], v7, s[12:15], s17 offen sc1
  s_add_u32 s17, s17, 55296
  s_waitcnt lgkmcnt(6)
  buffer_store_dwordx4 v[14:17], v7, s[12:15], s17 offen sc1
  s_add_u32 s17, s17, 55296
  s_waitcnt lgkmcnt(4)
  buffer_store_dwordx4 v[18:21], v7, s[12:15], s17 offen sc1
  s_add_u32 s17, s17, 55296
  s_waitcnt lgkmcnt(2)
  buffer_store_dwordx4 v[22:25], v7, s[12:15], s17 offen sc1
  s_add_u32 s17, s17, 55296
  s_waitcnt lgkmcnt(0)
  buffer_store_dwordx4 v[26:29], v7, s[12:15], s17 offen sc1
  s_add_u32 s17, s17, 55296
  s_endpgm
L_kg:
  s_setprio 2
  s_load_dwordx16 s[4:19], s[0:1], 8
  s_load_dwordx2 s[20:21], s[0:1], 120
  v_and_b32 v1, 63, v0
  v_lshrrev_b32 v2, 6, v0
  s_nop 0
  v_readfirstlane_b32 s3, v2
  v_lshlrev_b32 v3, 2, v1
  v_lshlrev_b32 v4, 12, v2
  s_lshl_b32 s2, s2, 2
  s_lshr_b32 s68, s3, 1
  s_and_b32 s69, s3, 1
  s_add_u32 s2, s2, s68
  s_lshl_b32 s22, s2, 8
  s_lshl_b32 s23, s2, 1
  v_mov_b32 v5, 0
  s_waitcnt lgkmcnt(0)
  s_mov_b32 s24, s4
  s_mov_b32 s25, s5
  s_mov_b32 s26, 163840
  s_mov_b32 s27, 0x00020000
  s_mov_b32 s28, s6
  s_mov_b32 s29, s7
  s_mov_b32 s30, 163840
  s_mov_b32 s31, 0x00020000
  s_mov_b32 s32, s8
  s_mov_b32 s33, s9
  s_mov_b32 s34, 163840
  s_mov_b32 s35, 0x00020000
  s_mov_b32 s36, s10
  s_mov_b32 s37, s11
  s_mov_b32 s38, 163840
  s_mov_b32 s39, 0x00020000
  s_mov_b32 s40, s12
  s_mov_b32 s41, s13
  s_mov_b32 s42, 163840
  s_mov_b32 s43, 0x00020000
  s_mov_b32 s44, s14
  s_mov_b32 s45, s15
  s_mov_b32 s46, 163840
  s_mov_b32 s47, 0x00020000
  s_mov_b32 s48, s16
  s_mov_b32 s49, s17
  s_mov_b32 s50, 1280
  s_mov_b32 s51, 0x00020000
  s_add_u32 s52, s20, 13631488
  s_addc_u32 s53, s21, 0
  s_mov_b32 s54, 2662400
  s_mov_b32 s55, 0x00020000
  s_add_u32 s56, s20, 16777216
  s_addc_u32 s57, s21, 0
  s_mov_b32 s58, 2560
  s_mov_b32 s59, 0x00020000
  buffer_load_ushort v16, v5, s[48:51], s23 offen
  buffer_load_dword v10, v3, s[24:27], s22 offen
  buffer_load_dword v11, v3, s[28:31], s22 offen
  buffer_load_dword v12, v3, s[32:35], s22 offen
  buffer_load_dword v13, v3, s[36:39], s22 offen
  buffer_load_dword v14, v3, s[40:43], s22 offen
  buffer_load_dword v15, v3, s[44:47], s22 offen
  s_waitcnt vmcnt(0)
  v_lshlrev_b32 v16, 16, v16
  v_mul_f32 v16, 0x3fb8aa3b, v16
  v_exp_f32 v16, v16
  s_nop 0
  v_cvt_pk_bf16_f32 v16, v16, v16
  v_lshlrev_b32 v16, 16, v16
  v_lshlrev_b32 v22, 16, v12
  v_and_b32 v28, 0xffff0000, v12
  v_lshlrev_b32 v23, 16, v13
  v_and_b32 v29, 0xffff0000, v13
  v_lshlrev_b32 v24, 16, v14
  v_and_b32 v30, 0xffff0000, v14
  v_lshlrev_b32 v25, 16, v15
  v_and_b32 v31, 0xffff0000, v15
  v_mul_f32 v22, v16, v22
  v_mul_f32 v23, v16, v23
  v_mul_f32 v40, v24, v22
  v_mul_f32 v41, v24, v23
  v_fma_f32 v40, -v25, v23, v40
  v_fma_f32 v41, v25, v22, v41
  v_mul_f32 v28, v16, v28
  v_mul_f32 v29, v16, v29
  v_mul_f32 v42, v30, v28
  v_mul_f32 v43, v30, v29
  v_fma_f32 v42, -v31, v29, v42
  v_fma_f32 v43, v31, v28, v43
  v_max_f32 v17, |v40|, |v41|
  v_max3_f32 v17, |v42|, |v43|, v17
  s_nop 1
  v_max_f32_dpp v17, v17, v17 quad_perm:[1,0,3,2] row_mask:0xf bank_mask:0xf
  s_nop 1
  v_max_f32_dpp v17, v17, v17 quad_perm:[2,3,0,1] row_mask:0xf bank_mask:0xf
  s_nop 1
  v_max_f32_dpp v17, v17, v17 row_half_mirror row_mask:0xf bank_mask:0xf
  s_nop 1
  v_max_f32_dpp v17, v17, v17 row_mirror row_mask:0xf bank_mask:0xf
  s_nop 0
  v_readlane_b32 s60, v17, 0
  v_readlane_b32 s61, v17, 16
  v_readlane_b32 s62, v17, 32
  v_readlane_b32 s63, v17, 48
  s_cmp_eq_u32 s69, 0
  s_cselect_b32 s64, 16, 0
  s_cselect_b64 s[66:67], -1, 0
  v_lshlrev_b32 v20, s64, v10
  v_lshlrev_b32 v21, s64, v11
  v_and_b32 v20, 0xffff0000, v20
  v_and_b32 v21, 0xffff0000, v21
  v_cndmask_b32 v44, v42, v40, s[66:67]
  v_cndmask_b32 v45, v43, v41, s[66:67]
  s_max_u32 s60, s60, s61
  s_max_u32 s62, s62, s63
  s_max_u32 s60, s60, s62
  s_lshr_b32 s60, s60, 23
  s_max_u32 s60, s60, 7
  s_min_u32 s60, s60, 254
  s_sub_u32 s61, 260, s60
  s_lshl_b32 s61, s61, 23
  s_sub_u32 s62, s60, 6
  s_lshl_b32 s62, s62, 23
  v_mul_f32 v32, v16, v20
  v_mul_f32 v33, v16, v21
  v_mul_f32 v32, 0x3fb8aa3b, v32
  v_mul_f32 v33, 0x3e22f983, v33
  v_mul_f32 v44, s61, v44
  v_mul_f32 v45, s61, v45
  v_mul_f32 v56, 0x43800000, v32
  v_mul_f32 v57, 0x43800000, v33
  v_mul_f32 v60, 0x44000000, v32
  v_mul_f32 v61, 0x44000000, v33
  v_mul_f32 v64, 0x44c00000, v32
  v_mul_f32 v65, 0x44c00000, v33
  v_exp_f32 v56, v56
  v_fract_f32 v57, v57
  v_exp_f32 v60, v60
  v_fract_f32 v61, v61
  v_exp_f32 v64, v64
  v_fract_f32 v65, v65
  v_cos_f32 v58, v57
  v_sin_f32 v59, v57
  v_cos_f32 v62, v61
  v_sin_f32 v63, v61
  v_cos_f32 v66, v65
  v_sin_f32 v67, v65
  v_mul_f32 v58, v58, v56
  v_mul_f32 v59, v59, v56
  v_mul_f32 v62, v62, v60
  v_mul_f32 v63, v63, v60
  v_mul_f32 v66, v66, v64
  v_mul_f32 v67, v67, v64
  v_mul_f32 v46, v44, v58
  v_mul_f32 v47, v44, v59
  v_fma_f32 v46, -v45, v59, v46
  v_fma_f32 v47, v45, v58, v47
  v_mul_f32 v48, v44, v62
  v_mul_f32 v49, v44, v63
  v_fma_f32 v48, -v45, v63, v48
  v_fma_f32 v49, v45, v62, v49
  v_mul_f32 v50, v44, v66
  v_mul_f32 v51, v44, v67
  v_fma_f32 v50, -v45, v67, v50
  v_fma_f32 v51, v45, v66, v51
  v_lshl_add_u32 v6, v1, 3, v4
  v_lshl_add_u32 v7, v1, 4, v4
  v_cvt_pk_f16_f32 v52, v44, v45
  v_cvt_pk_f16_f32 v53, v46, v47
  v_cvt_pk_f16_f32 v54, v48, v49
  v_cvt_pk_f16_f32 v55, v50, v51
  ds_write_b64 v6, v[32:33] offset:0
  ds_write_b128 v7, v[52:55] offset:512
  v_mov_b32 v8, s62
  s_lshl_b32 s23, s2, 2
  buffer_store_dword v8, v5, s[56:59], s23 offen
  v_and_b32 v8, 15, v1
  v_lshrrev_b32 v9, 4, v1
  v_cvt_f32_u32 v10, v8
  v_lshl_add_u32 v12, v9, 5, v4
  v_lshl_add_u32 v13, v9, 6, v4
  ds_read_b128 v[16:19], v12 offset:0
  ds_read_b128 v[20:23], v12 offset:16
  s_waitcnt lgkmcnt(0)
  v_mul_f32 v64, v16, v10
  v_mul_f32 v66, v18, v10
  v_mul_f32 v68, v20, v10
  v_mul_f32 v70, v22, v10
  v_mul_f32 v65, v17, v10
  v_mul_f32 v67, v19, v10
  v_mul_f32 v69, v21, v10
  v_mul_f32 v71, v23, v10
  ds_read_b128 v[24:27], v13 offset:512
  ds_read_b128 v[28:31], v13 offset:528
  ds_read_b128 v[32:35], v13 offset:544
  ds_read_b128 v[36:39], v13 offset:560
  ds_read_b128 v[16:19], v12 offset:128
  ds_read_b128 v[20:23], v12 offset:144
  v_exp_f32 v64, v64
  v_exp_f32 v66, v66
  v_exp_f32 v68, v68
  v_exp_f32 v70, v70
  v_fract_f32 v65, v65
  v_fract_f32 v67, v67
  v_fract_f32 v69, v69
  v_fract_f32 v71, v71
  v_cos_f32 v56, v65
  v_cos_f32 v58, v67
  v_cos_f32 v60, v69
  v_cos_f32 v62, v71
  v_sin_f32 v57, v65
  v_sin_f32 v59, v67
  v_sin_f32 v61, v69
  v_sin_f32 v63, v71
  v_mul_f32 v56, v56, v64
  v_mul_f32 v58, v58, v66
  v_mul_f32 v60, v60, v68
  v_mul_f32 v62, v62, v70
  v_mul_f32 v57, v57, v64
  v_mul_f32 v59, v59, v66
  v_mul_f32 v61, v61, v68
  v_mul_f32 v63, v63, v70
  v_cvt_pk_f16_f32 v80, v56, v57
  v_cvt_pk_f16_f32 v81, v58, v59
  v_cvt_pk_f16_f32 v82, v60, v61
  v_cvt_pk_f16_f32 v83, v62, v63
  v_mul_f32 v64, v57, v57
  v_mul_f32 v66, v59, v59
  v_mul_f32 v68, v61, v61
  v_mul_f32 v70, v63, v63
  v_mul_f32 v57, v56, v57 mul:2
  v_mul_f32 v59, v58, v59 mul:2
  v_mul_f32 v61, v60, v61 mul:2
  v_mul_f32 v63, v62, v63 mul:2
  v_fma_f32 v56, v56, v56, -v64
  v_fma_f32 v58, v58, v58, -v66
  v_fma_f32 v60, v60, v60, -v68
  v_fma_f32 v62, v62, v62, -v70
  v_mul_f32 v64, v57, v57
  v_mul_f32 v66, v59, v59
  v_mul_f32 v68, v61, v61
  v_mul_f32 v70, v63, v63
  v_mul_f32 v57, v56, v57 mul:2
  v_mul_f32 v59, v58, v59 mul:2
  v_mul_f32 v61, v60, v61 mul:2
  v_mul_f32 v63, v62, v63 mul:2
  v_fma_f32 v56, v56, v56, -v64
  v_fma_f32 v58, v58, v58, -v66
  v_fma_f32 v60, v60, v60, -v68
  v_fma_f32 v62, v62, v62, -v70
  v_cvt_pk_f16_f32 v84, v56, v57
  v_cvt_pk_f16_f32 v85, v58, v59
  v_cvt_pk_f16_f32 v86, v60, v61
  v_cvt_pk_f16_f32 v87, v62, v63
  v_mul_f32 v64, v57, v57
  v_mul_f32 v66, v59, v59
  v_mul_f32 v68, v61, v61
  v_mul_f32 v70, v63, v63
  v_mul_f32 v57, v56, v57 mul:2
  v_mul_f32 v59, v58, v59 mul:2
  v_mul_f32 v61, v60, v61 mul:2
  v_mul_f32 v63, v62, v63 mul:2
  v_fma_f32 v56, v56, v56, -v64
  v_fma_f32 v58, v58, v58, -v66
  v_fma_f32 v60, v60, v60, -v68
  v_fma_f32 v62, v62, v62, -v70
  v_mul_f32 v64, v57, v57
  v_mul_f32 v66, v59, v59
  v_mul_f32 v68, v61, v61
  v_mul_f32 v70, v63, v63
  v_mul_f32 v57, v56, v57 mul:2
  v_mul_f32 v59, v58, v59 mul:2
  v_mul_f32 v61, v60, v61 mul:2
  v_mul_f32 v63, v62, v63 mul:2
  v_fma_f32 v56, v56, v56, -v64
  v_fma_f32 v58, v58, v58, -v66
  v_fma_f32 v60, v60, v60, -v68
  v_fma_f32 v62, v62, v62, -v70
  s_waitcnt lgkmcnt(2)
  v_cvt_pk_f16_f32 v72, v56, v57
  v_cvt_pk_f16_f32 v73, v58, v59
  v_cvt_pk_f16_f32 v74, v60, v61
  v_cvt_pk_f16_f32 v75, v62, v63
  v_pk_mul_f16 v88, v24, v72 op_sel:[0,0] op_sel_hi:[0,1] neg_hi:[1,0]
  v_pk_mul_f16 v89, v28, v73 op_sel:[0,0] op_sel_hi:[0,1] neg_hi:[1,0]
  v_pk_mul_f16 v90, v32, v74 op_sel:[0,0] op_sel_hi:[0,1] neg_hi:[1,0]
  v_pk_mul_f16 v91, v36, v75 op_sel:[0,0] op_sel_hi:[0,1] neg_hi:[1,0]
  v_pk_fma_f16 v88, v24, v72, v88 op_sel:[1,1,0] op_sel_hi:[1,0,1] neg_lo:[1,0,0] neg_hi:[1,0,0]
  v_pk_fma_f16 v89, v28, v73, v89 op_sel:[1,1,0] op_sel_hi:[1,0,1] neg_lo:[1,0,0] neg_hi:[1,0,0]
  v_pk_fma_f16 v90, v32, v74, v90 op_sel:[1,1,0] op_sel_hi:[1,0,1] neg_lo:[1,0,0] neg_hi:[1,0,0]
  v_pk_fma_f16 v91, v36, v75, v91 op_sel:[1,1,0] op_sel_hi:[1,0,1] neg_lo:[1,0,0] neg_hi:[1,0,0]
  v_pk_mul_f16 v92, v25, v72 op_sel:[0,0] op_sel_hi:[0,1] neg_hi:[1,0]
  v_pk_mul_f16 v93, v29, v73 op_sel:[0,0] op_sel_hi:[0,1] neg_hi:[1,0]
  v_pk_mul_f16 v94, v33, v74 op_sel:[0,0] op_sel_hi:[0,1] neg_hi:[1,0]
  v_pk_mul_f16 v95, v37, v75 op_sel:[0,0] op_sel_hi:[0,1] neg_hi:[1,0]
  v_pk_fma_f16 v92, v25, v72, v92 op_sel:[1,1,0] op_sel_hi:[1,0,1] neg_lo:[1,0,0] neg_hi:[1,0,0]
  v_pk_fma_f16 v93, v29, v73, v93 op_sel:[1,1,0] op_sel_hi:[1,0,1] neg_lo:[1,0,0] neg_hi:[1,0,0]
  v_pk_fma_f16 v94, v33, v74, v94 op_sel:[1,1,0] op_sel_hi:[1,0,1] neg_lo:[1,0,0] neg_hi:[1,0,0]
  v_pk_fma_f16 v95, v37, v75, v95 op_sel:[1,1,0] op_sel_hi:[1,0,1] neg_lo:[1,0,0] neg_hi:[1,0,0]
  v_mul_f32 v64, v57, v57
  v_mul_f32 v66, v59, v59
  v_mul_f32 v68, v61, v61
  v_mul_f32 v70, v63, v63
  v_mul_f32 v57, v56, v57 mul:2
  v_mul_f32 v59, v58, v59 mul:2
  v_mul_f32 v61, v60, v61 mul:2
  v_mul_f32 v63, v62, v63 mul:2
  v_fma_f32 v56, v56, v56, -v64
  v_fma_f32 v58, v58, v58, -v66
  v_fma_f32 v60, v60, v60, -v68
  v_fma_f32 v62, v62, v62, -v70
  v_mul_f32 v64, v57, v57
  v_mul_f32 v66, v59, v59
  v_mul_f32 v68, v61, v61
  v_mul_f32 v70, v63, v63
  v_mul_f32 v57, v56, v57 mul:2
  v_mul_f32 v59, v58, v59 mul:2
  v_mul_f32 v61, v60, v61 mul:2
  v_mul_f32 v63, v62, v63 mul:2
  v_fma_f32 v56, v56, v56, -v64
  v_fma_f32 v58, v58, v58, -v66
  v_fma_f32 v60, v60, v60, -v68
  v_fma_f32 v62, v62, v62, -v70
  v_mfma_f32_16x16x32_f16 v[104:107], v[80:83], v[88:91], 0
  v_mfma_f32_16x16x32_f16 v[108:111], v[80:83], v[92:95], 0
  v_cvt_pk_f16_f32 v72, v56, v57
  v_cvt_pk_f16_f32 v73, v58, v59
  v_cvt_pk_f16_f32 v74, v60, v61
  v_cvt_pk_f16_f32 v75, v62, v63
  v_pk_mul_f16 v96, v26, v72 op_sel:[0,0] op_sel_hi:[0,1] neg_hi:[1,0]
  v_pk_mul_f16 v97, v30, v73 op_sel:[0,0] op_sel_hi:[0,1] neg_hi:[1,0]
  v_pk_mul_f16 v98, v34, v74 op_sel:[0,0] op_sel_hi:[0,1] neg_hi:[1,0]
  v_pk_mul_f16 v99, v38, v75 op_sel:[0,0] op_sel_hi:[0,1] neg_hi:[1,0]
  v_pk_fma_f16 v96, v26, v72, v96 op_sel:[1,1,0] op_sel_hi:[1,0,1] neg_lo:[1,0,0] neg_hi:[1,0,0]
  v_pk_fma_f16 v97, v30, v73, v97 op_sel:[1,1,0] op_sel_hi:[1,0,1] neg_lo:[1,0,0] neg_hi:[1,0,0]
  v_pk_fma_f16 v98, v34, v74, v98 op_sel:[1,1,0] op_sel_hi:[1,0,1] neg_lo:[1,0,0] neg_hi:[1,0,0]
  v_pk_fma_f16 v99, v38, v75, v99 op_sel:[1,1,0] op_sel_hi:[1,0,1] neg_lo:[1,0,0] neg_hi:[1,0,0]
  v_pk_mul_f16 v100, v27, v72 op_sel:[0,0] op_sel_hi:[0,1] neg_hi:[1,0]
  v_pk_mul_f16 v101, v31, v73 op_sel:[0,0] op_sel_hi:[0,1] neg_hi:[1,0]
  v_pk_mul_f16 v102, v35, v74 op_sel:[0,0] op_sel_hi:[0,1] neg_hi:[1,0]
  v_pk_mul_f16 v103, v39, v75 op_sel:[0,0] op_sel_hi:[0,1] neg_hi:[1,0]
  v_pk_fma_f16 v100, v27, v72, v100 op_sel:[1,1,0] op_sel_hi:[1,0,1] neg_lo:[1,0,0] neg_hi:[1,0,0]
  v_pk_fma_f16 v101, v31, v73, v101 op_sel:[1,1,0] op_sel_hi:[1,0,1] neg_lo:[1,0,0] neg_hi:[1,0,0]
  v_pk_fma_f16 v102, v35, v74, v102 op_sel:[1,1,0] op_sel_hi:[1,0,1] neg_lo:[1,0,0] neg_hi:[1,0,0]
  v_pk_fma_f16 v103, v39, v75, v103 op_sel:[1,1,0] op_sel_hi:[1,0,1] neg_lo:[1,0,0] neg_hi:[1,0,0]
  v_mfma_f32_16x16x32_f16 v[112:115], v[84:87], v[96:99], 0
  s_nop 0
  v_mfma_f32_16x16x32_f16 v[116:119], v[84:87], v[100:103], 0
  s_waitcnt lgkmcnt(0)
  v_mul_f32 v64, v16, v10
  v_mul_f32 v66, v18, v10
  v_mul_f32 v68, v20, v10
  v_mul_f32 v70, v22, v10
  v_mul_f32 v65, v17, v10
  v_mul_f32 v67, v19, v10
  v_mul_f32 v69, v21, v10
  v_mul_f32 v71, v23, v10
  ds_read_b128 v[24:27], v13 offset:768
  ds_read_b128 v[28:31], v13 offset:784
  ds_read_b128 v[32:35], v13 offset:800
  ds_read_b128 v[36:39], v13 offset:816
  ds_read_b128 v[16:19], v12 offset:256
  ds_read_b128 v[20:23], v12 offset:272
  v_exp_f32 v64, v64
  v_exp_f32 v66, v66
  v_exp_f32 v68, v68
  v_exp_f32 v70, v70
  v_fract_f32 v65, v65
  v_fract_f32 v67, v67
  v_fract_f32 v69, v69
  v_fract_f32 v71, v71
  v_cos_f32 v56, v65
  v_cos_f32 v58, v67
  v_cos_f32 v60, v69
  v_cos_f32 v62, v71
  v_sin_f32 v57, v65
  v_sin_f32 v59, v67
  v_sin_f32 v61, v69
  v_sin_f32 v63, v71
  v_mul_f32 v56, v56, v64
  v_mul_f32 v58, v58, v66
  v_mul_f32 v60, v60, v68
  v_mul_f32 v62, v62, v70
  v_mul_f32 v57, v57, v64
  v_mul_f32 v59, v59, v66
  v_mul_f32 v61, v61, v68
  v_mul_f32 v63, v63, v70
  v_cvt_pk_f16_f32 v80, v56, v57
  v_cvt_pk_f16_f32 v81, v58, v59
  v_cvt_pk_f16_f32 v82, v60, v61
  v_cvt_pk_f16_f32 v83, v62, v63
  v_mul_f32 v64, v57, v57
  v_mul_f32 v66, v59, v59
  v_mul_f32 v68, v61, v61
  v_mul_f32 v70, v63, v63
  v_mul_f32 v57, v56, v57 mul:2
  v_mul_f32 v59, v58, v59 mul:2
  v_mul_f32 v61, v60, v61 mul:2
  v_mul_f32 v63, v62, v63 mul:2
  v_fma_f32 v56, v56, v56, -v64
  v_fma_f32 v58, v58, v58, -v66
  v_fma_f32 v60, v60, v60, -v68
  v_fma_f32 v62, v62, v62, -v70
  v_mul_f32 v64, v57, v57
  v_mul_f32 v66, v59, v59
  v_mul_f32 v68, v61, v61
  v_mul_f32 v70, v63, v63
  v_mul_f32 v57, v56, v57 mul:2
  v_mul_f32 v59, v58, v59 mul:2
  v_mul_f32 v61, v60, v61 mul:2
  v_mul_f32 v63, v62, v63 mul:2
  v_fma_f32 v56, v56, v56, -v64
  v_fma_f32 v58, v58, v58, -v66
  v_fma_f32 v60, v60, v60, -v68
  v_fma_f32 v62, v62, v62, -v70
  v_cvt_pk_f16_f32 v84, v56, v57
  v_cvt_pk_f16_f32 v85, v58, v59
  v_cvt_pk_f16_f32 v86, v60, v61
  v_cvt_pk_f16_f32 v87, v62, v63
  v_mul_f32 v64, v57, v57
  v_mul_f32 v66, v59, v59
  v_mul_f32 v68, v61, v61
  v_mul_f32 v70, v63, v63
  v_mul_f32 v57, v56, v57 mul:2
  v_mul_f32 v59, v58, v59 mul:2
  v_mul_f32 v61, v60, v61 mul:2
  v_mul_f32 v63, v62, v63 mul:2
  v_fma_f32 v56, v56, v56, -v64
  v_fma_f32 v58, v58, v58, -v66
  v_fma_f32 v60, v60, v60, -v68
  v_fma_f32 v62, v62, v62, -v70
  v_mul_f32 v64, v57, v57
  v_mul_f32 v66, v59, v59
  v_mul_f32 v68, v61, v61
  v_mul_f32 v70, v63, v63
  v_mul_f32 v57, v56, v57 mul:2
  v_mul_f32 v59, v58, v59 mul:2
  v_mul_f32 v61, v60, v61 mul:2
  v_mul_f32 v63, v62, v63 mul:2
  v_fma_f32 v56, v56, v56, -v64
  v_fma_f32 v58, v58, v58, -v66
  v_fma_f32 v60, v60, v60, -v68
  v_fma_f32 v62, v62, v62, -v70
  s_waitcnt lgkmcnt(2)
  v_cvt_pk_f16_f32 v72, v56, v57
  v_cvt_pk_f16_f32 v73, v58, v59
  v_cvt_pk_f16_f32 v74, v60, v61
  v_cvt_pk_f16_f32 v75, v62, v63
  v_pk_mul_f16 v88, v24, v72 op_sel:[0,0] op_sel_hi:[0,1] neg_hi:[1,0]
  v_pk_mul_f16 v89, v28, v73 op_sel:[0,0] op_sel_hi:[0,1] neg_hi:[1,0]
  v_pk_mul_f16 v90, v32, v74 op_sel:[0,0] op_sel_hi:[0,1] neg_hi:[1,0]
  v_pk_mul_f16 v91, v36, v75 op_sel:[0,0] op_sel_hi:[0,1] neg_hi:[1,0]
  v_pk_fma_f16 v88, v24, v72, v88 op_sel:[1,1,0] op_sel_hi:[1,0,1] neg_lo:[1,0,0] neg_hi:[1,0,0]
  v_pk_fma_f16 v89, v28, v73, v89 op_sel:[1,1,0] op_sel_hi:[1,0,1] neg_lo:[1,0,0] neg_hi:[1,0,0]
  v_pk_fma_f16 v90, v32, v74, v90 op_sel:[1,1,0] op_sel_hi:[1,0,1] neg_lo:[1,0,0] neg_hi:[1,0,0]
  v_pk_fma_f16 v91, v36, v75, v91 op_sel:[1,1,0] op_sel_hi:[1,0,1] neg_lo:[1,0,0] neg_hi:[1,0,0]
  v_pk_mul_f16 v92, v25, v72 op_sel:[0,0] op_sel_hi:[0,1] neg_hi:[1,0]
  v_pk_mul_f16 v93, v29, v73 op_sel:[0,0] op_sel_hi:[0,1] neg_hi:[1,0]
  v_pk_mul_f16 v94, v33, v74 op_sel:[0,0] op_sel_hi:[0,1] neg_hi:[1,0]
  v_pk_mul_f16 v95, v37, v75 op_sel:[0,0] op_sel_hi:[0,1] neg_hi:[1,0]
  v_pk_fma_f16 v92, v25, v72, v92 op_sel:[1,1,0] op_sel_hi:[1,0,1] neg_lo:[1,0,0] neg_hi:[1,0,0]
  v_pk_fma_f16 v93, v29, v73, v93 op_sel:[1,1,0] op_sel_hi:[1,0,1] neg_lo:[1,0,0] neg_hi:[1,0,0]
  v_pk_fma_f16 v94, v33, v74, v94 op_sel:[1,1,0] op_sel_hi:[1,0,1] neg_lo:[1,0,0] neg_hi:[1,0,0]
  v_pk_fma_f16 v95, v37, v75, v95 op_sel:[1,1,0] op_sel_hi:[1,0,1] neg_lo:[1,0,0] neg_hi:[1,0,0]
  v_mul_f32 v64, v57, v57
  v_mul_f32 v66, v59, v59
  v_mul_f32 v68, v61, v61
  v_mul_f32 v70, v63, v63
  v_mul_f32 v57, v56, v57 mul:2
  v_mul_f32 v59, v58, v59 mul:2
  v_mul_f32 v61, v60, v61 mul:2
  v_mul_f32 v63, v62, v63 mul:2
  v_fma_f32 v56, v56, v56, -v64
  v_fma_f32 v58, v58, v58, -v66
  v_fma_f32 v60, v60, v60, -v68
  v_fma_f32 v62, v62, v62, -v70
  v_mul_f32 v64, v57, v57
  v_mul_f32 v66, v59, v59
  v_mul_f32 v68, v61, v61
  v_mul_f32 v70, v63, v63
  v_mul_f32 v57, v56, v57 mul:2
  v_mul_f32 v59, v58, v59 mul:2
  v_mul_f32 v61, v60, v61 mul:2
  v_mul_f32 v63, v62, v63 mul:2
  v_fma_f32 v56, v56, v56, -v64
  v_fma_f32 v58, v58, v58, -v66
  v_fma_f32 v60, v60, v60, -v68
  v_fma_f32 v62, v62, v62, -v70
  v_mfma_f32_16x16x32_f16 v[104:107], v[80:83], v[88:91], v[104:107]
  v_mfma_f32_16x16x32_f16 v[108:111], v[80:83], v[92:95], v[108:111]
  v_cvt_pk_f16_f32 v72, v56, v57
  v_cvt_pk_f16_f32 v73, v58, v59
  v_cvt_pk_f16_f32 v74, v60, v61
  v_cvt_pk_f16_f32 v75, v62, v63
  v_pk_mul_f16 v96, v26, v72 op_sel:[0,0] op_sel_hi:[0,1] neg_hi:[1,0]
  v_pk_mul_f16 v97, v30, v73 op_sel:[0,0] op_sel_hi:[0,1] neg_hi:[1,0]
  v_pk_mul_f16 v98, v34, v74 op_sel:[0,0] op_sel_hi:[0,1] neg_hi:[1,0]
  v_pk_mul_f16 v99, v38, v75 op_sel:[0,0] op_sel_hi:[0,1] neg_hi:[1,0]
  v_pk_fma_f16 v96, v26, v72, v96 op_sel:[1,1,0] op_sel_hi:[1,0,1] neg_lo:[1,0,0] neg_hi:[1,0,0]
  v_pk_fma_f16 v97, v30, v73, v97 op_sel:[1,1,0] op_sel_hi:[1,0,1] neg_lo:[1,0,0] neg_hi:[1,0,0]
  v_pk_fma_f16 v98, v34, v74, v98 op_sel:[1,1,0] op_sel_hi:[1,0,1] neg_lo:[1,0,0] neg_hi:[1,0,0]
  v_pk_fma_f16 v99, v38, v75, v99 op_sel:[1,1,0] op_sel_hi:[1,0,1] neg_lo:[1,0,0] neg_hi:[1,0,0]
  v_pk_mul_f16 v100, v27, v72 op_sel:[0,0] op_sel_hi:[0,1] neg_hi:[1,0]
  v_pk_mul_f16 v101, v31, v73 op_sel:[0,0] op_sel_hi:[0,1] neg_hi:[1,0]
  v_pk_mul_f16 v102, v35, v74 op_sel:[0,0] op_sel_hi:[0,1] neg_hi:[1,0]
  v_pk_mul_f16 v103, v39, v75 op_sel:[0,0] op_sel_hi:[0,1] neg_hi:[1,0]
  v_pk_fma_f16 v100, v27, v72, v100 op_sel:[1,1,0] op_sel_hi:[1,0,1] neg_lo:[1,0,0] neg_hi:[1,0,0]
  v_pk_fma_f16 v101, v31, v73, v101 op_sel:[1,1,0] op_sel_hi:[1,0,1] neg_lo:[1,0,0] neg_hi:[1,0,0]
  v_pk_fma_f16 v102, v35, v74, v102 op_sel:[1,1,0] op_sel_hi:[1,0,1] neg_lo:[1,0,0] neg_hi:[1,0,0]
  v_pk_fma_f16 v103, v39, v75, v103 op_sel:[1,1,0] op_sel_hi:[1,0,1] neg_lo:[1,0,0] neg_hi:[1,0,0]
  v_mfma_f32_16x16x32_f16 v[112:115], v[84:87], v[96:99], v[112:115]
  s_nop 0
  v_mfma_f32_16x16x32_f16 v[116:119], v[84:87], v[100:103], v[116:119]
  s_waitcnt lgkmcnt(0)
  v_mul_f32 v64, v16, v10
  v_mul_f32 v66, v18, v10
  v_mul_f32 v68, v20, v10
  v_mul_f32 v70, v22, v10
  v_mul_f32 v65, v17, v10
  v_mul_f32 v67, v19, v10
  v_mul_f32 v69, v21, v10
  v_mul_f32 v71, v23, v10
  ds_read_b128 v[24:27], v13 offset:1024
  ds_read_b128 v[28:31], v13 offset:1040
  ds_read_b128 v[32:35], v13 offset:1056
  ds_read_b128 v[36:39], v13 offset:1072
  ds_read_b128 v[16:19], v12 offset:384
  ds_read_b128 v[20:23], v12 offset:400
  v_exp_f32 v64, v64
  v_exp_f32 v66, v66
  v_exp_f32 v68, v68
  v_exp_f32 v70, v70
  v_fract_f32 v65, v65
  v_fract_f32 v67, v67
  v_fract_f32 v69, v69
  v_fract_f32 v71, v71
  v_cos_f32 v56, v65
  v_cos_f32 v58, v67
  v_cos_f32 v60, v69
  v_cos_f32 v62, v71
  v_sin_f32 v57, v65
  v_sin_f32 v59, v67
  v_sin_f32 v61, v69
  v_sin_f32 v63, v71
  v_mul_f32 v56, v56, v64
  v_mul_f32 v58, v58, v66
  v_mul_f32 v60, v60, v68
  v_mul_f32 v62, v62, v70
  v_mul_f32 v57, v57, v64
  v_mul_f32 v59, v59, v66
  v_mul_f32 v61, v61, v68
  v_mul_f32 v63, v63, v70
  v_cvt_pk_f16_f32 v80, v56, v57
  v_cvt_pk_f16_f32 v81, v58, v59
  v_cvt_pk_f16_f32 v82, v60, v61
  v_cvt_pk_f16_f32 v83, v62, v63
  v_mul_f32 v64, v57, v57
  v_mul_f32 v66, v59, v59
  v_mul_f32 v68, v61, v61
  v_mul_f32 v70, v63, v63
  v_mul_f32 v57, v56, v57 mul:2
  v_mul_f32 v59, v58, v59 mul:2
  v_mul_f32 v61, v60, v61 mul:2
  v_mul_f32 v63, v62, v63 mul:2
  v_fma_f32 v56, v56, v56, -v64
  v_fma_f32 v58, v58, v58, -v66
  v_fma_f32 v60, v60, v60, -v68
  v_fma_f32 v62, v62, v62, -v70
  v_mul_f32 v64, v57, v57
  v_mul_f32 v66, v59, v59
  v_mul_f32 v68, v61, v61
  v_mul_f32 v70, v63, v63
  v_mul_f32 v57, v56, v57 mul:2
  v_mul_f32 v59, v58, v59 mul:2
  v_mul_f32 v61, v60, v61 mul:2
  v_mul_f32 v63, v62, v63 mul:2
  v_fma_f32 v56, v56, v56, -v64
  v_fma_f32 v58, v58, v58, -v66
  v_fma_f32 v60, v60, v60, -v68
  v_fma_f32 v62, v62, v62, -v70
  v_cvt_pk_f16_f32 v84, v56, v57
  v_cvt_pk_f16_f32 v85, v58, v59
  v_cvt_pk_f16_f32 v86, v60, v61
  v_cvt_pk_f16_f32 v87, v62, v63
  v_mul_f32 v64, v57, v57
  v_mul_f32 v66, v59, v59
  v_mul_f32 v68, v61, v61
  v_mul_f32 v70, v63, v63
  v_mul_f32 v57, v56, v57 mul:2
  v_mul_f32 v59, v58, v59 mul:2
  v_mul_f32 v61, v60, v61 mul:2
  v_mul_f32 v63, v62, v63 mul:2
  v_fma_f32 v56, v56, v56, -v64
  v_fma_f32 v58, v58, v58, -v66
  v_fma_f32 v60, v60, v60, -v68
  v_fma_f32 v62, v62, v62, -v70
  v_mul_f32 v64, v57, v57
  v_mul_f32 v66, v59, v59
  v_mul_f32 v68, v61, v61
  v_mul_f32 v70, v63, v63
  v_mul_f32 v57, v56, v57 mul:2
  v_mul_f32 v59, v58, v59 mul:2
  v_mul_f32 v61, v60, v61 mul:2
  v_mul_f32 v63, v62, v63 mul:2
  v_fma_f32 v56, v56, v56, -v64
  v_fma_f32 v58, v58, v58, -v66
  v_fma_f32 v60, v60, v60, -v68
  v_fma_f32 v62, v62, v62, -v70
  s_waitcnt lgkmcnt(2)
  v_cvt_pk_f16_f32 v72, v56, v57
  v_cvt_pk_f16_f32 v73, v58, v59
  v_cvt_pk_f16_f32 v74, v60, v61
  v_cvt_pk_f16_f32 v75, v62, v63
  v_pk_mul_f16 v88, v24, v72 op_sel:[0,0] op_sel_hi:[0,1] neg_hi:[1,0]
  v_pk_mul_f16 v89, v28, v73 op_sel:[0,0] op_sel_hi:[0,1] neg_hi:[1,0]
  v_pk_mul_f16 v90, v32, v74 op_sel:[0,0] op_sel_hi:[0,1] neg_hi:[1,0]
  v_pk_mul_f16 v91, v36, v75 op_sel:[0,0] op_sel_hi:[0,1] neg_hi:[1,0]
  v_pk_fma_f16 v88, v24, v72, v88 op_sel:[1,1,0] op_sel_hi:[1,0,1] neg_lo:[1,0,0] neg_hi:[1,0,0]
  v_pk_fma_f16 v89, v28, v73, v89 op_sel:[1,1,0] op_sel_hi:[1,0,1] neg_lo:[1,0,0] neg_hi:[1,0,0]
  v_pk_fma_f16 v90, v32, v74, v90 op_sel:[1,1,0] op_sel_hi:[1,0,1] neg_lo:[1,0,0] neg_hi:[1,0,0]
  v_pk_fma_f16 v91, v36, v75, v91 op_sel:[1,1,0] op_sel_hi:[1,0,1] neg_lo:[1,0,0] neg_hi:[1,0,0]
  v_pk_mul_f16 v92, v25, v72 op_sel:[0,0] op_sel_hi:[0,1] neg_hi:[1,0]
  v_pk_mul_f16 v93, v29, v73 op_sel:[0,0] op_sel_hi:[0,1] neg_hi:[1,0]
  v_pk_mul_f16 v94, v33, v74 op_sel:[0,0] op_sel_hi:[0,1] neg_hi:[1,0]
  v_pk_mul_f16 v95, v37, v75 op_sel:[0,0] op_sel_hi:[0,1] neg_hi:[1,0]
  v_pk_fma_f16 v92, v25, v72, v92 op_sel:[1,1,0] op_sel_hi:[1,0,1] neg_lo:[1,0,0] neg_hi:[1,0,0]
  v_pk_fma_f16 v93, v29, v73, v93 op_sel:[1,1,0] op_sel_hi:[1,0,1] neg_lo:[1,0,0] neg_hi:[1,0,0]
  v_pk_fma_f16 v94, v33, v74, v94 op_sel:[1,1,0] op_sel_hi:[1,0,1] neg_lo:[1,0,0] neg_hi:[1,0,0]
  v_pk_fma_f16 v95, v37, v75, v95 op_sel:[1,1,0] op_sel_hi:[1,0,1] neg_lo:[1,0,0] neg_hi:[1,0,0]
  v_mul_f32 v64, v57, v57
  v_mul_f32 v66, v59, v59
  v_mul_f32 v68, v61, v61
  v_mul_f32 v70, v63, v63
  v_mul_f32 v57, v56, v57 mul:2
  v_mul_f32 v59, v58, v59 mul:2
  v_mul_f32 v61, v60, v61 mul:2
  v_mul_f32 v63, v62, v63 mul:2
  v_fma_f32 v56, v56, v56, -v64
  v_fma_f32 v58, v58, v58, -v66
  v_fma_f32 v60, v60, v60, -v68
  v_fma_f32 v62, v62, v62, -v70
  v_mul_f32 v64, v57, v57
  v_mul_f32 v66, v59, v59
  v_mul_f32 v68, v61, v61
  v_mul_f32 v70, v63, v63
  v_mul_f32 v57, v56, v57 mul:2
  v_mul_f32 v59, v58, v59 mul:2
  v_mul_f32 v61, v60, v61 mul:2
  v_mul_f32 v63, v62, v63 mul:2
  v_fma_f32 v56, v56, v56, -v64
  v_fma_f32 v58, v58, v58, -v66
  v_fma_f32 v60, v60, v60, -v68
  v_fma_f32 v62, v62, v62, -v70
  v_mfma_f32_16x16x32_f16 v[104:107], v[80:83], v[88:91], v[104:107]
  v_mfma_f32_16x16x32_f16 v[108:111], v[80:83], v[92:95], v[108:111]
  v_cvt_pk_f16_f32 v72, v56, v57
  v_cvt_pk_f16_f32 v73, v58, v59
  v_cvt_pk_f16_f32 v74, v60, v61
  v_cvt_pk_f16_f32 v75, v62, v63
  v_pk_mul_f16 v96, v26, v72 op_sel:[0,0] op_sel_hi:[0,1] neg_hi:[1,0]
  v_pk_mul_f16 v97, v30, v73 op_sel:[0,0] op_sel_hi:[0,1] neg_hi:[1,0]
  v_pk_mul_f16 v98, v34, v74 op_sel:[0,0] op_sel_hi:[0,1] neg_hi:[1,0]
  v_pk_mul_f16 v99, v38, v75 op_sel:[0,0] op_sel_hi:[0,1] neg_hi:[1,0]
  v_pk_fma_f16 v96, v26, v72, v96 op_sel:[1,1,0] op_sel_hi:[1,0,1] neg_lo:[1,0,0] neg_hi:[1,0,0]
  v_pk_fma_f16 v97, v30, v73, v97 op_sel:[1,1,0] op_sel_hi:[1,0,1] neg_lo:[1,0,0] neg_hi:[1,0,0]
  v_pk_fma_f16 v98, v34, v74, v98 op_sel:[1,1,0] op_sel_hi:[1,0,1] neg_lo:[1,0,0] neg_hi:[1,0,0]
  v_pk_fma_f16 v99, v38, v75, v99 op_sel:[1,1,0] op_sel_hi:[1,0,1] neg_lo:[1,0,0] neg_hi:[1,0,0]
  v_pk_mul_f16 v100, v27, v72 op_sel:[0,0] op_sel_hi:[0,1] neg_hi:[1,0]
  v_pk_mul_f16 v101, v31, v73 op_sel:[0,0] op_sel_hi:[0,1] neg_hi:[1,0]
  v_pk_mul_f16 v102, v35, v74 op_sel:[0,0] op_sel_hi:[0,1] neg_hi:[1,0]
  v_pk_mul_f16 v103, v39, v75 op_sel:[0,0] op_sel_hi:[0,1] neg_hi:[1,0]
  v_pk_fma_f16 v100, v27, v72, v100 op_sel:[1,1,0] op_sel_hi:[1,0,1] neg_lo:[1,0,0] neg_hi:[1,0,0]
  v_pk_fma_f16 v101, v31, v73, v101 op_sel:[1,1,0] op_sel_hi:[1,0,1] neg_lo:[1,0,0] neg_hi:[1,0,0]
  v_pk_fma_f16 v102, v35, v74, v102 op_sel:[1,1,0] op_sel_hi:[1,0,1] neg_lo:[1,0,0] neg_hi:[1,0,0]
  v_pk_fma_f16 v103, v39, v75, v103 op_sel:[1,1,0] op_sel_hi:[1,0,1] neg_lo:[1,0,0] neg_hi:[1,0,0]
  v_mfma_f32_16x16x32_f16 v[112:115], v[84:87], v[96:99], v[112:115]
  s_nop 0
  v_mfma_f32_16x16x32_f16 v[116:119], v[84:87], v[100:103], v[116:119]
  s_waitcnt lgkmcnt(0)
  v_mul_f32 v64, v16, v10
  v_mul_f32 v66, v18, v10
  v_mul_f32 v68, v20, v10
  v_mul_f32 v70, v22, v10
  v_mul_f32 v65, v17, v10
  v_mul_f32 v67, v19, v10
  v_mul_f32 v69, v21, v10
  v_mul_f32 v71, v23, v10
  ds_read_b128 v[24:27], v13 offset:1280
  ds_read_b128 v[28:31], v13 offset:1296
  ds_read_b128 v[32:35], v13 offset:1312
  ds_read_b128 v[36:39], v13 offset:1328
  v_exp_f32 v64, v64
  v_exp_f32 v66, v66
  v_exp_f32 v68, v68
  v_exp_f32 v70, v70
  v_fract_f32 v65, v65
  v_fract_f32 v67, v67
  v_fract_f32 v69, v69
  v_fract_f32 v71, v71
  v_cos_f32 v56, v65
  v_cos_f32 v58, v67
  v_cos_f32 v60, v69
  v_cos_f32 v62, v71
  v_sin_f32 v57, v65
  v_sin_f32 v59, v67
  v_sin_f32 v61, v69
  v_sin_f32 v63, v71
  v_mul_f32 v56, v56, v64
  v_mul_f32 v58, v58, v66
  v_mul_f32 v60, v60, v68
  v_mul_f32 v62, v62, v70
  v_mul_f32 v57, v57, v64
  v_mul_f32 v59, v59, v66
  v_mul_f32 v61, v61, v68
  v_mul_f32 v63, v63, v70
  v_cvt_pk_f16_f32 v80, v56, v57
  v_cvt_pk_f16_f32 v81, v58, v59
  v_cvt_pk_f16_f32 v82, v60, v61
  v_cvt_pk_f16_f32 v83, v62, v63
  v_mul_f32 v64, v57, v57
  v_mul_f32 v66, v59, v59
  v_mul_f32 v68, v61, v61
  v_mul_f32 v70, v63, v63
  v_mul_f32 v57, v56, v57 mul:2
  v_mul_f32 v59, v58, v59 mul:2
  v_mul_f32 v61, v60, v61 mul:2
  v_mul_f32 v63, v62, v63 mul:2
  v_fma_f32 v56, v56, v56, -v64
  v_fma_f32 v58, v58, v58, -v66
  v_fma_f32 v60, v60, v60, -v68
  v_fma_f32 v62, v62, v62, -v70
  v_mul_f32 v64, v57, v57
  v_mul_f32 v66, v59, v59
  v_mul_f32 v68, v61, v61
  v_mul_f32 v70, v63, v63
  v_mul_f32 v57, v56, v57 mul:2
  v_mul_f32 v59, v58, v59 mul:2
  v_mul_f32 v61, v60, v61 mul:2
  v_mul_f32 v63, v62, v63 mul:2
  v_fma_f32 v56, v56, v56, -v64
  v_fma_f32 v58, v58, v58, -v66
  v_fma_f32 v60, v60, v60, -v68
  v_fma_f32 v62, v62, v62, -v70
  v_cvt_pk_f16_f32 v84, v56, v57
  v_cvt_pk_f16_f32 v85, v58, v59
  v_cvt_pk_f16_f32 v86, v60, v61
  v_cvt_pk_f16_f32 v87, v62, v63
  v_mul_f32 v64, v57, v57
  v_mul_f32 v66, v59, v59
  v_mul_f32 v68, v61, v61
  v_mul_f32 v70, v63, v63
  v_mul_f32 v57, v56, v57 mul:2
  v_mul_f32 v59, v58, v59 mul:2
  v_mul_f32 v61, v60, v61 mul:2
  v_mul_f32 v63, v62, v63 mul:2
  v_fma_f32 v56, v56, v56, -v64
  v_fma_f32 v58, v58, v58, -v66
  v_fma_f32 v60, v60, v60, -v68
  v_fma_f32 v62, v62, v62, -v70
  v_mul_f32 v64, v57, v57
  v_mul_f32 v66, v59, v59
  v_mul_f32 v68, v61, v61
  v_mul_f32 v70, v63, v63
  v_mul_f32 v57, v56, v57 mul:2
  v_mul_f32 v59, v58, v59 mul:2
  v_mul_f32 v61, v60, v61 mul:2
  v_mul_f32 v63, v62, v63 mul:2
  v_fma_f32 v56, v56, v56, -v64
  v_fma_f32 v58, v58, v58, -v66
  v_fma_f32 v60, v60, v60, -v68
  v_fma_f32 v62, v62, v62, -v70
  s_waitcnt lgkmcnt(0)
  v_cvt_pk_f16_f32 v72, v56, v57
  v_cvt_pk_f16_f32 v73, v58, v59
  v_cvt_pk_f16_f32 v74, v60, v61
  v_cvt_pk_f16_f32 v75, v62, v63
  v_pk_mul_f16 v88, v24, v72 op_sel:[0,0] op_sel_hi:[0,1] neg_hi:[1,0]
  v_pk_mul_f16 v89, v28, v73 op_sel:[0,0] op_sel_hi:[0,1] neg_hi:[1,0]
  v_pk_mul_f16 v90, v32, v74 op_sel:[0,0] op_sel_hi:[0,1] neg_hi:[1,0]
  v_pk_mul_f16 v91, v36, v75 op_sel:[0,0] op_sel_hi:[0,1] neg_hi:[1,0]
  v_pk_fma_f16 v88, v24, v72, v88 op_sel:[1,1,0] op_sel_hi:[1,0,1] neg_lo:[1,0,0] neg_hi:[1,0,0]
  v_pk_fma_f16 v89, v28, v73, v89 op_sel:[1,1,0] op_sel_hi:[1,0,1] neg_lo:[1,0,0] neg_hi:[1,0,0]
  v_pk_fma_f16 v90, v32, v74, v90 op_sel:[1,1,0] op_sel_hi:[1,0,1] neg_lo:[1,0,0] neg_hi:[1,0,0]
  v_pk_fma_f16 v91, v36, v75, v91 op_sel:[1,1,0] op_sel_hi:[1,0,1] neg_lo:[1,0,0] neg_hi:[1,0,0]
  v_pk_mul_f16 v92, v25, v72 op_sel:[0,0] op_sel_hi:[0,1] neg_hi:[1,0]
  v_pk_mul_f16 v93, v29, v73 op_sel:[0,0] op_sel_hi:[0,1] neg_hi:[1,0]
  v_pk_mul_f16 v94, v33, v74 op_sel:[0,0] op_sel_hi:[0,1] neg_hi:[1,0]
  v_pk_mul_f16 v95, v37, v75 op_sel:[0,0] op_sel_hi:[0,1] neg_hi:[1,0]
  v_pk_fma_f16 v92, v25, v72, v92 op_sel:[1,1,0] op_sel_hi:[1,0,1] neg_lo:[1,0,0] neg_hi:[1,0,0]
  v_pk_fma_f16 v93, v29, v73, v93 op_sel:[1,1,0] op_sel_hi:[1,0,1] neg_lo:[1,0,0] neg_hi:[1,0,0]
  v_pk_fma_f16 v94, v33, v74, v94 op_sel:[1,1,0] op_sel_hi:[1,0,1] neg_lo:[1,0,0] neg_hi:[1,0,0]
  v_pk_fma_f16 v95, v37, v75, v95 op_sel:[1,1,0] op_sel_hi:[1,0,1] neg_lo:[1,0,0] neg_hi:[1,0,0]
  v_mul_f32 v64, v57, v57
  v_mul_f32 v66, v59, v59
  v_mul_f32 v68, v61, v61
  v_mul_f32 v70, v63, v63
  v_mul_f32 v57, v56, v57 mul:2
  v_mul_f32 v59, v58, v59 mul:2
  v_mul_f32 v61, v60, v61 mul:2
  v_mul_f32 v63, v62, v63 mul:2
  v_fma_f32 v56, v56, v56, -v64
  v_fma_f32 v58, v58, v58, -v66
  v_fma_f32 v60, v60, v60, -v68
  v_fma_f32 v62, v62, v62, -v70
  v_mul_f32 v64, v57, v57
  v_mul_f32 v66, v59, v59
  v_mul_f32 v68, v61, v61
  v_mul_f32 v70, v63, v63
  v_mul_f32 v57, v56, v57 mul:2
  v_mul_f32 v59, v58, v59 mul:2
  v_mul_f32 v61, v60, v61 mul:2
  v_mul_f32 v63, v62, v63 mul:2
  v_fma_f32 v56, v56, v56, -v64
  v_fma_f32 v58, v58, v58, -v66
  v_fma_f32 v60, v60, v60, -v68
  v_fma_f32 v62, v62, v62, -v70
  v_mfma_f32_16x16x32_f16 v[104:107], v[80:83], v[88:91], v[104:107]
  v_mfma_f32_16x16x32_f16 v[108:111], v[80:83], v[92:95], v[108:111]
  v_cvt_pk_f16_f32 v72, v56, v57
  v_cvt_pk_f16_f32 v73, v58, v59
  v_cvt_pk_f16_f32 v74, v60, v61
  v_cvt_pk_f16_f32 v75, v62, v63
  v_pk_mul_f16 v96, v26, v72 op_sel:[0,0] op_sel_hi:[0,1] neg_hi:[1,0]
  v_pk_mul_f16 v97, v30, v73 op_sel:[0,0] op_sel_hi:[0,1] neg_hi:[1,0]
  v_pk_mul_f16 v98, v34, v74 op_sel:[0,0] op_sel_hi:[0,1] neg_hi:[1,0]
  v_pk_mul_f16 v99, v38, v75 op_sel:[0,0] op_sel_hi:[0,1] neg_hi:[1,0]
  v_pk_fma_f16 v96, v26, v72, v96 op_sel:[1,1,0] op_sel_hi:[1,0,1] neg_lo:[1,0,0] neg_hi:[1,0,0]
  v_pk_fma_f16 v97, v30, v73, v97 op_sel:[1,1,0] op_sel_hi:[1,0,1] neg_lo:[1,0,0] neg_hi:[1,0,0]
  v_pk_fma_f16 v98, v34, v74, v98 op_sel:[1,1,0] op_sel_hi:[1,0,1] neg_lo:[1,0,0] neg_hi:[1,0,0]
  v_pk_fma_f16 v99, v38, v75, v99 op_sel:[1,1,0] op_sel_hi:[1,0,1] neg_lo:[1,0,0] neg_hi:[1,0,0]
  v_pk_mul_f16 v100, v27, v72 op_sel:[0,0] op_sel_hi:[0,1] neg_hi:[1,0]
  v_pk_mul_f16 v101, v31, v73 op_sel:[0,0] op_sel_hi:[0,1] neg_hi:[1,0]
  v_pk_mul_f16 v102, v35, v74 op_sel:[0,0] op_sel_hi:[0,1] neg_hi:[1,0]
  v_pk_mul_f16 v103, v39, v75 op_sel:[0,0] op_sel_hi:[0,1] neg_hi:[1,0]
  v_pk_fma_f16 v100, v27, v72, v100 op_sel:[1,1,0] op_sel_hi:[1,0,1] neg_lo:[1,0,0] neg_hi:[1,0,0]
  v_pk_fma_f16 v101, v31, v73, v101 op_sel:[1,1,0] op_sel_hi:[1,0,1] neg_lo:[1,0,0] neg_hi:[1,0,0]
  v_pk_fma_f16 v102, v35, v74, v102 op_sel:[1,1,0] op_sel_hi:[1,0,1] neg_lo:[1,0,0] neg_hi:[1,0,0]
  v_pk_fma_f16 v103, v39, v75, v103 op_sel:[1,1,0] op_sel_hi:[1,0,1] neg_lo:[1,0,0] neg_hi:[1,0,0]
  v_mfma_f32_16x16x32_f16 v[112:115], v[84:87], v[96:99], v[112:115]
  s_nop 0
  v_mfma_f32_16x16x32_f16 v[116:119], v[84:87], v[100:103], v[116:119]
  v_lshl_add_u32 v14, v1, 4, v4
  v_xor_b32 v15, 4096, v14
  s_cmp_eq_u32 s69, 0
  s_cselect_b64 exec, -1, 0
  s_nop 1
  ds_write_b128 v14, v[112:115] offset:32768
  s_nop 0
  ds_write_b128 v14, v[116:119] offset:33792
  s_not_b64 exec, exec
  ds_write_b128 v14, v[104:107] offset:32768
  ds_write_b128 v14, v[108:111] offset:33792
  s_waitcnt lgkmcnt(0)
  v_mov_b32 v104, v112
  v_mov_b32 v105, v113
  v_mov_b32 v106, v114
  v_mov_b32 v107, v115
  v_mov_b32 v108, v116
  v_mov_b32 v109, v117
  v_mov_b32 v110, v118
  v_mov_b32 v111, v119
  s_mov_b64 exec, -1
  s_barrier
  ds_read_b128 v[16:19], v15 offset:32768
  ds_read_b128 v[20:23], v15 offset:33792
  s_mul_i32 s70, s68, 2304
  s_add_u32 s70, s70, 65536
  s_lshl_b32 s71, s69, 10
  s_add_u32 s71, s71, s70
  v_lshlrev_b32 v14, 5, v8
  v_lshl_add_u32 v14, v9, 3, v14
  v_add_u32 v14, s71, v14
  s_waitcnt lgkmcnt(0)
  v_add_f32 v16, v16, v104
  v_add_f32 v17, v17, v105
  v_add_f32 v18, v18, v106
  v_add_f32 v19, v19, v107
  v_add_f32 v20, v20, v108
  v_add_f32 v21, v21, v109
  v_add_f32 v22, v22, v110
  v_add_f32 v23, v23, v111
  v_cvt_pk_f16_f32 v24, v16, v17
  v_cvt_pk_f16_f32 v25, v18, v19
  ds_write_b64 v14, v[24:25] offset:0
  v_cvt_pk_f16_f32 v26, v20, v21
  v_cvt_pk_f16_f32 v27, v22, v23
  ds_write_b64 v14, v[26:27] offset:512
  v_sub_u32 v15, 127, v1
  v_lshlrev_b32 v15, 2, v15
  v_add_u32 v15, s70, v15
  v_sub_u32 v16, 63, v1
  v_lshlrev_b32 v16, 4, v16
  v_add_u32 v16, s70, v16
  s_mov_b32 s63, 0x01000100
  s_mov_b32 s64, 0x03020302
  s_mov_b32 s65, 0x01000302
  v_and_b32 v17, 1, v1
  v_cmp_eq_u32 s[66:67], 1, v17
  v_mov_b32 v18, 0x05040504
  v_mov_b32 v19, 0x01000504
  v_cndmask_b32 v17, v18, v19, s[66:67]
  v_cmp_le_u32 s[66:67], 32, v1
  v_mov_b32 v33, 0x01000302
  v_mov_b32 v34, 0x01000100
  v_cndmask_b32 v18, v19, v33, s[66:67]
  v_cndmask_b32 v19, v34, v33, s[66:67]
  v_lshlrev_b32 v35, 4, v1
  s_mul_i32 s22, s2, 4160
  s_waitcnt lgkmcnt(0)
  s_barrier
  s_cmp_eq_u32 s69, 0
  s_cbranch_scc0 kg_h1
  v_add_u32 v15, 1024, v15
  ds_read2_b32 v[20:21], v15 offset0:64 offset1:65
  ds_read2_b32 v[22:23], v15 offset0:0 offset1:1
  s_waitcnt lgkmcnt(1)
  v_perm_b32 v40, v21, v21, s63
  v_perm_b32 v41, v21, v20, v17
  v_perm_b32 v42, v20, v20, s63
  v_mov_b32 v43, v42
  buffer_store_dwordx4 v[40:43], v35, s[52:55], s22 offen offset:0 sc1
  s_waitcnt lgkmcnt(0)
  v_perm_b32 v44, v23, v23, s63
  v_perm_b32 v45, v23, v22, v17
  v_perm_b32 v46, v22, v22, s63
  v_mov_b32 v47, v46
  buffer_store_dwordx4 v[44:47], v35, s[52:55], s22 offen offset:1024 sc1
  s_endpgm
kg_h1:
  ds_read2_b32 v[24:25], v15 offset0:192 offset1:193
  ds_read_b128 v[28:31], v16
  ds_read_b32 v32, v16 offset:16
  v_mov_b32 v56, 0
  v_mov_b32 v57, 0
  v_mov_b32 v58, 0
  v_mov_b32 v59, 0
  s_waitcnt lgkmcnt(2)
  v_perm_b32 v48, v25, v25, s63
  v_perm_b32 v49, v24, v24, s64
  v_perm_b32 v50, v24, v24, s65
  v_perm_b32 v51, v24, v24, s63
  buffer_store_dwordx4 v[48:51], v35, s[52:55], s22 offen offset:2048 sc1
  s_waitcnt lgkmcnt(0)
  v_perm_b32 v52, v32, v31, v18
  v_perm_b32 v53, v30, v30, v19
  v_perm_b32 v54, v30, v29, v18
  v_perm_b32 v55, v28, v28, v19
  buffer_store_dwordx4 v[52:55], v35, s[52:55], s22 offen offset:3072 sc1
  s_add_u32 s22, s22, 4096
  buffer_store_dwordx4 v[56:59], v5, s[52:55], s22 offen sc1
  s_endpgm
L_g1:
  s_setprio 3
  s_load_dwordx2 s[4:5], s[0:1], 0
  s_load_dwordx2 s[6:7], s[0:1], 120
  s_load_dwordx4 s[24:27], s[0:1], 80
  s_load_dwordx2 s[48:49], s[0:1], 112
  s_and_b32 s3, s2, 7
  s_lshr_b32 s28, s2, 3
  s_and_b32 s29, s3, 3
  s_lshl_b32 s29, s29, 2
  s_and_b32 s30, s28, 3
  s_add_u32 s29, s29, s30
  s_lshr_b32 s30, s3, 2
  s_mul_i32 s30, s30, 7
  s_lshr_b32 s31, s28, 2
  s_add_u32 s30, s30, s31
  v_and_b32 v104, 63, v0
  v_lshrrev_b32 v2, 6, v0
  s_nop 0
  v_readfirstlane_b32 s31, v2
  v_lshrrev_b32 v3, 3, v104
  v_and_b32 v4, 7, v104
  v_lshrrev_b32 v5, 1, v3
  v_xor_b32 v4, v4, v5
  v_mul_u32_u24 v78, 1280, v3
  v_lshl_add_u32 v78, v4, 4, v78
  v_xor_b32 v105, 64, v78
  v_lshrrev_b32 v3, 4, v104
  v_and_b32 v4, 15, v104
  v_lshlrev_b32 v5, 2, v3
  v_xor_b32 v4, v4, v5
  v_mul_u32_u24 v79, 3456, v3
  v_lshl_add_u32 v79, v4, 4, v79
  s_and_b32 s32, s31, 3
  s_lshr_b32 s33, s31, 2
  s_waitcnt lgkmcnt(0)
  s_mov_b32 s8, s4
  s_mov_b32 s9, s5
  s_mov_b32 s10, 2621440
  s_mov_b32 s11, 0x00020000
  s_mov_b32 s12, s24
  s_mov_b32 s13, s25
  s_mov_b32 s14, 2211840
  s_mov_b32 s15, 0x00020000
  s_lshl_b32 s36, s29, 3
  s_add_u32 s36, s36, s31
  s_mul_i32 s36, s36, 20480
  s_mul_i32 s38, s31, 13824
  s_lshl_b32 s3, s30, 8
  s_add_u32 s38, s38, s3
  s_lshl_b32 s39, s31, 10
  s_add_u32 s62, s29, s30
  s_and_b32 s62, s62, 3
  s_mul_i32 s62, s62, 5
  s_lshr_b32 s62, s62, 1
  s_mul_i32 s63, s62, 221184
  s_lshl_b32 s62, s62, 7
  s_lshl_b32 s37, s31, 11
  s_add_u32 m0, s37, 0
  s_add_u32 s40, s36, s62
  buffer_load_dwordx4 v78, s[8:11], s40 offen lds
  s_add_u32 m0, s37, 1024
  s_add_u32 s40, s36, s62
  s_add_u32 s40, s40, 10240
  buffer_load_dwordx4 v105, s[8:11], s40 offen lds
  s_add_u32 s62, s62, 128
  s_cmp_eq_u32 s62, 1280
  s_cselect_b32 s62, 0, s62
  s_add_u32 m0, s39, 49152
  s_add_u32 s40, s38, s63
  buffer_load_dwordx4 v79, s[12:15], s40 offen lds
  s_add_u32 s63, s63, 110592
  s_add_u32 m0, s39, 57344
  s_add_u32 s40, s38, s63
  buffer_load_dwordx4 v79, s[12:15], s40 offen lds
  s_add_u32 s63, s63, 110592
  s_cmp_eq_u32 s63, 2211840
  s_cselect_b32 s63, 0, s63
  s_add_u32 m0, s37, 16384
  s_add_u32 s40, s36, s62
  buffer_load_dwordx4 v78, s[8:11], s40 offen lds
  s_add_u32 m0, s37, 17408
  s_add_u32 s40, s36, s62
  s_add_u32 s40, s40, 10240
  buffer_load_dwordx4 v105, s[8:11], s40 offen lds
  s_add_u32 s62, s62, 128
  s_cmp_eq_u32 s62, 1280
  s_cselect_b32 s62, 0, s62
  s_add_u32 m0, s39, 65536
  s_add_u32 s40, s38, s63
  buffer_load_dwordx4 v79, s[12:15], s40 offen lds
  s_add_u32 s63, s63, 110592
  s_mov_b32 s16, s6
  s_mov_b32 s17, s7
  s_mov_b32 s18, 7077888
  s_mov_b32 s19, 0x00020000
  s_mov_b32 s20, s26
  s_mov_b32 s21, s27
  s_mov_b32 s22, 3456
  s_mov_b32 s23, 0x00020000
  v_and_b32 v3, 31, v104
  v_lshrrev_b32 v4, 5, v104
  v_lshrrev_b32 v5, 2, v2
  v_and_b32 v6, 3, v2
  v_lshrrev_b32 v11, 1, v6
  v_xor_b32 v11, v11, v5
  v_mov_b32 v12, 0
  v_and_b32 v13, 1, v6
  v_lshl_add_u32 v7, v4, 1, v11
  v_lshrrev_b32 v8, 1, v3
  v_and_b32 v8, 7, v8
  v_xor_b32 v8, v8, v7
  v_lshl_add_u32 v9, v6, 5, v3
  v_lshlrev_b32 v112, 7, v9
  v_lshl_add_u32 v112, v8, 4, v112
  v_lshl_add_u32 v112, v12, 3, v112
  v_xor_b32 v113, 8, v112
  v_xor_b32 v114, 16, v112
  v_xor_b32 v115, 24, v112
  v_xor_b32 v116, 64, v112
  v_xor_b32 v117, 72, v112
  v_xor_b32 v118, 80, v112
  v_xor_b32 v119, 88, v112
  v_and_b32 v8, 15, v104
  v_lshrrev_b32 v9, 2, v8
  v_lshl_add_u32 v10, v7, 3, v9
  v_lshl_add_u32 v10, v12, 2, v10
  v_lshlrev_b32 v80, 8, v10
  v_lshlrev_b32 v10, 1, v5
  v_xor_b32 v10, v10, v9
  v_lshl_add_u32 v80, v10, 6, v80
  v_lshrrev_b32 v10, 4, v104
  v_and_b32 v10, 1, v10
  v_lshl_add_u32 v80, v10, 5, v80
  v_and_b32 v10, 3, v8
  v_lshl_add_u32 v80, v10, 3, v80
  v_add_u32 v80, 49152, v80
  v_xor_b32 v81, 1024, v80
  v_xor_b32 v82, 64, v80
  v_xor_b32 v83, 1088, v80
  v_xor_b32 v84, 2048, v80
  v_xor_b32 v85, 3072, v80
  v_xor_b32 v86, 2112, v80
  v_xor_b32 v87, 3136, v80
  v_and_b32 v8, 3, v104
  v_lshl_add_u32 v8, v13, 3, v8
  v_mov_b32 v9, 0
  v_mov_b32 v10, 0x3f803f80
  v_cmp_eq_u32 s[44:45], 0, v8
  s_nop 1
  v_cndmask_b32 v72, v9, v10, s[44:45]
  v_cndmask_b32 v73, v9, v10, s[44:45]
  v_cmp_eq_u32 s[44:45], 1, v8
  s_nop 1
  v_cndmask_b32 v74, v9, v10, s[44:45]
  v_cndmask_b32 v75, v9, v10, s[44:45]
  v_cmp_eq_u32 s[44:45], 2, v8
  s_nop 1
  v_cndmask_b32 v76, v9, v10, s[44:45]
  v_cndmask_b32 v77, v9, v10, s[44:45]
  v_mov_b32 v64, 0
  v_mov_b32 v120, 0
  v_mov_b32 v68, 0
  v_mov_b32 v65, 0
  v_mov_b32 v121, 0
  v_mov_b32 v69, 0
  v_mov_b32 v66, 0
  v_mov_b32 v122, 0
  v_mov_b32 v70, 0
  v_mov_b32 v67, 0
  v_mov_b32 v123, 0
  v_mov_b32 v71, 0
  v_lshlrev_b32 v8, 3, v4
  s_lshl_b32 s41, s33, 7
  s_add_u32 s41, s41, s3
  v_lshlrev_b32 v111, 1, v104
  s_setprio 1
  s_waitcnt vmcnt(4)
  s_barrier
  ds_read_b128 v[32:35], v112 offset:0
  ds_read_b64_tr_b16 v[44:45], v80 offset:0
  ds_read_b64_tr_b16 v[46:47], v81 offset:0
  ds_read_b64_tr_b16 v[48:49], v82 offset:0
  ds_read_b64_tr_b16 v[50:51], v83 offset:0
  ds_read_b128 v[36:39], v114 offset:0
  ds_read_b64_tr_b16 v[52:53], v84 offset:0
  ds_read_b64_tr_b16 v[54:55], v85 offset:0
  ds_read_b64_tr_b16 v[56:57], v86 offset:0
  ds_read_b64_tr_b16 v[58:59], v87 offset:0
  s_mov_b32 s52, s48
  s_mov_b32 s53, s49
  s_mov_b32 s54, 256
  s_mov_b32 s55, 0x00020000
  s_add_u32 s56, s6, 22020096
  s_addc_u32 s57, s7, 0
  s_mov_b32 s58, 16384
  s_mov_b32 s59, 0x00020000
  s_lshl_b32 s50, s29, 2
  s_add_u32 s50, s50, s32
  s_lshl_b32 s51, s50, 8
  s_lshl_b32 s50, s50, 2
  v_and_b32 v70, 31, v104
  v_lshlrev_b32 v70, 3, v70
  s_waitcnt vmcnt(3)
  s_barrier
  s_waitcnt lgkmcnt(5)
  v_mfma_f32_32x32x16_bf16 v[0:15], v[44:47], v[32:35], 0
  ds_read_b128 v[40:43], v116 offset:0
  ds_read_b64_tr_b16 v[60:61], v80 offset:8192
  ds_read_b64_tr_b16 v[62:63], v81 offset:8192
  s_add_u32 m0, s39, 73728
  s_add_u32 s40, s38, s63
  buffer_load_dwordx4 v79, s[12:15], s40 offen lds
  s_add_u32 s63, s63, 110592
  s_cmp_eq_u32 s63, 2211840
  s_cselect_b32 s63, 0, s63
  v_mfma_f32_32x32x16_bf16 v[16:31], v[48:51], v[32:35], 0
  ds_read_b64_tr_b16 v[44:45], v82 offset:8192
  ds_read_b64_tr_b16 v[46:47], v83 offset:8192
  s_add_u32 m0, s37, 32768
  s_add_u32 s40, s36, s62
  buffer_load_dwordx4 v78, s[8:11], s40 offen lds
  s_waitcnt lgkmcnt(5)
  v_mfma_f32_32x32x16_bf16 v[0:15], v[52:55], v[36:39], v[0:15]
  ds_read_b128 v[32:35], v118 offset:0
  ds_read_b64_tr_b16 v[48:49], v84 offset:8192
  ds_read_b64_tr_b16 v[50:51], v85 offset:8192
  s_add_u32 m0, s37, 33792
  s_add_u32 s40, s36, s62
  s_add_u32 s40, s40, 10240
  buffer_load_dwordx4 v105, s[8:11], s40 offen lds
  s_add_u32 s62, s62, 128
  s_cmp_eq_u32 s62, 1280
  s_cselect_b32 s62, 0, s62
  v_mfma_f32_4x4x4_16b_bf16 v[64:67], v[72:73], v[52:53], v[64:67]
  v_mfma_f32_4x4x4_16b_bf16 v[120:123], v[72:73], v[54:55], v[120:123]
  v_mfma_f32_32x32x16_bf16 v[16:31], v[56:59], v[36:39], v[16:31]
  ds_read_b64_tr_b16 v[52:53], v86 offset:8192
  ds_read_b64_tr_b16 v[54:55], v87 offset:8192
  v_mfma_f32_4x4x4_16b_bf16 v[64:67], v[74:75], v[56:57], v[64:67]
  v_mfma_f32_4x4x4_16b_bf16 v[120:123], v[74:75], v[58:59], v[120:123]
  s_waitcnt vmcnt(3)
  s_barrier
  s_waitcnt lgkmcnt(5)
  v_mfma_f32_32x32x16_bf16 v[0:15], v[60:63], v[40:43], v[0:15]
  ds_read_b128 v[36:39], v112 offset:16384
  ds_read_b64_tr_b16 v[56:57], v80 offset:16384
  ds_read_b64_tr_b16 v[58:59], v81 offset:16384
  s_add_u32 m0, s39, 49152
  s_add_u32 s40, s38, s63
  buffer_load_dwordx4 v79, s[12:15], s40 offen lds
  s_add_u32 s63, s63, 110592
  v_mfma_f32_32x32x16_bf16 v[16:31], v[44:47], v[40:43], v[16:31]
  ds_read_b64_tr_b16 v[60:61], v82 offset:16384
  ds_read_b64_tr_b16 v[62:63], v83 offset:16384
  s_waitcnt lgkmcnt(5)
  v_mfma_f32_32x32x16_bf16 v[0:15], v[48:51], v[32:35], v[0:15]
  ds_read_b128 v[40:43], v114 offset:16384
  ds_read_b64_tr_b16 v[44:45], v84 offset:16384
  ds_read_b64_tr_b16 v[46:47], v85 offset:16384
  v_mfma_f32_4x4x4_16b_bf16 v[64:67], v[72:73], v[48:49], v[64:67]
  v_mfma_f32_4x4x4_16b_bf16 v[120:123], v[72:73], v[50:51], v[120:123]
  v_mfma_f32_32x32x16_bf16 v[16:31], v[52:55], v[32:35], v[16:31]
  ds_read_b64_tr_b16 v[48:49], v86 offset:16384
  ds_read_b64_tr_b16 v[50:51], v87 offset:16384
  v_mfma_f32_4x4x4_16b_bf16 v[64:67], v[74:75], v[52:53], v[64:67]
  v_mfma_f32_4x4x4_16b_bf16 v[120:123], v[74:75], v[54:55], v[120:123]
  s_waitcnt vmcnt(3)
  s_barrier
  s_waitcnt lgkmcnt(5)
  v_mfma_f32_32x32x16_bf16 v[0:15], v[56:59], v[36:39], v[0:15]
  ds_read_b128 v[32:35], v116 offset:16384
  ds_read_b64_tr_b16 v[52:53], v80 offset:24576
  ds_read_b64_tr_b16 v[54:55], v81 offset:24576
  s_add_u32 m0, s39, 57344
  s_add_u32 s40, s38, s63
  buffer_load_dwordx4 v79, s[12:15], s40 offen lds
  s_add_u32 s63, s63, 110592
  s_cmp_eq_u32 s63, 2211840
  s_cselect_b32 s63, 0, s63
  v_mfma_f32_32x32x16_bf16 v[16:31], v[60:63], v[36:39], v[16:31]
  ds_read_b64_tr_b16 v[56:57], v82 offset:24576
  ds_read_b64_tr_b16 v[58:59], v83 offset:24576
  s_add_u32 m0, s37, 0
  s_add_u32 s40, s36, s62
  buffer_load_dwordx4 v78, s[8:11], s40 offen lds
  s_waitcnt lgkmcnt(5)
  v_mfma_f32_32x32x16_bf16 v[0:15], v[44:47], v[40:43], v[0:15]
  ds_read_b128 v[36:39], v118 offset:16384
  ds_read_b64_tr_b16 v[60:61], v84 offset:24576
  ds_read_b64_tr_b16 v[62:63], v85 offset:24576
  s_add_u32 m0, s37, 1024
  s_add_u32 s40, s36, s62
  s_add_u32 s40, s40, 10240
  buffer_load_dwordx4 v105, s[8:11], s40 offen lds
  s_add_u32 s62, s62, 128
  s_cmp_eq_u32 s62, 1280
  s_cselect_b32 s62, 0, s62
  v_mfma_f32_4x4x4_16b_bf16 v[64:67], v[72:73], v[44:45], v[64:67]
  v_mfma_f32_4x4x4_16b_bf16 v[120:123], v[72:73], v[46:47], v[120:123]
  v_mfma_f32_32x32x16_bf16 v[16:31], v[48:51], v[40:43], v[16:31]
  ds_read_b64_tr_b16 v[44:45], v86 offset:24576
  ds_read_b64_tr_b16 v[46:47], v87 offset:24576
  v_mfma_f32_4x4x4_16b_bf16 v[64:67], v[74:75], v[48:49], v[64:67]
  v_mfma_f32_4x4x4_16b_bf16 v[120:123], v[74:75], v[50:51], v[120:123]
  s_waitcnt vmcnt(3)
  s_barrier
  s_waitcnt lgkmcnt(5)
  v_mfma_f32_32x32x16_bf16 v[0:15], v[52:55], v[32:35], v[0:15]
  ds_read_b128 v[40:43], v112 offset:32768
  ds_read_b64_tr_b16 v[48:49], v80 offset:0
  ds_read_b64_tr_b16 v[50:51], v81 offset:0
  s_add_u32 m0, s39, 65536
  s_add_u32 s40, s38, s63
  buffer_load_dwordx4 v79, s[12:15], s40 offen lds
  s_add_u32 s63, s63, 110592
  v_mfma_f32_32x32x16_bf16 v[16:31], v[56:59], v[32:35], v[16:31]
  ds_read_b64_tr_b16 v[52:53], v82 offset:0
  ds_read_b64_tr_b16 v[54:55], v83 offset:0
  s_waitcnt lgkmcnt(5)
  v_mfma_f32_32x32x16_bf16 v[0:15], v[60:63], v[36:39], v[0:15]
  ds_read_b128 v[32:35], v114 offset:32768
  ds_read_b64_tr_b16 v[56:57], v84 offset:0
  ds_read_b64_tr_b16 v[58:59], v85 offset:0
  v_mfma_f32_4x4x4_16b_bf16 v[64:67], v[72:73], v[60:61], v[64:67]
  v_mfma_f32_4x4x4_16b_bf16 v[120:123], v[72:73], v[62:63], v[120:123]
  v_mfma_f32_32x32x16_bf16 v[16:31], v[44:47], v[36:39], v[16:31]
  ds_read_b64_tr_b16 v[60:61], v86 offset:0
  ds_read_b64_tr_b16 v[62:63], v87 offset:0
  v_mfma_f32_4x4x4_16b_bf16 v[64:67], v[74:75], v[44:45], v[64:67]
  v_mfma_f32_4x4x4_16b_bf16 v[120:123], v[74:75], v[46:47], v[120:123]
  s_waitcnt vmcnt(3)
  s_barrier
  s_waitcnt lgkmcnt(5)
  v_mfma_f32_32x32x16_bf16 v[0:15], v[48:51], v[40:43], v[0:15]
  ds_read_b128 v[36:39], v116 offset:32768
  ds_read_b64_tr_b16 v[44:45], v80 offset:8192
  ds_read_b64_tr_b16 v[46:47], v81 offset:8192
  s_add_u32 m0, s39, 73728
  s_add_u32 s40, s38, s63
  buffer_load_dwordx4 v79, s[12:15], s40 offen lds
  s_add_u32 s63, s63, 110592
  s_cmp_eq_u32 s63, 2211840
  s_cselect_b32 s63, 0, s63
  v_mfma_f32_32x32x16_bf16 v[16:31], v[52:55], v[40:43], v[16:31]
  ds_read_b64_tr_b16 v[48:49], v82 offset:8192
  ds_read_b64_tr_b16 v[50:51], v83 offset:8192
  s_add_u32 m0, s37, 16384
  s_add_u32 s40, s36, s62
  buffer_load_dwordx4 v78, s[8:11], s40 offen lds
  s_waitcnt lgkmcnt(5)
  v_mfma_f32_32x32x16_bf16 v[0:15], v[56:59], v[32:35], v[0:15]
  ds_read_b128 v[40:43], v118 offset:32768
  ds_read_b64_tr_b16 v[52:53], v84 offset:8192
  ds_read_b64_tr_b16 v[54:55], v85 offset:8192
  s_add_u32 m0, s37, 17408
  s_add_u32 s40, s36, s62
  s_add_u32 s40, s40, 10240
  buffer_load_dwordx4 v105, s[8:11], s40 offen lds
  s_add_u32 s62, s62, 128
  s_cmp_eq_u32 s62, 1280
  s_cselect_b32 s62, 0, s62
  v_mfma_f32_4x4x4_16b_bf16 v[64:67], v[72:73], v[56:57], v[64:67]
  v_mfma_f32_4x4x4_16b_bf16 v[120:123], v[72:73], v[58:59], v[120:123]
  v_mfma_f32_32x32x16_bf16 v[16:31], v[60:63], v[32:35], v[16:31]
  ds_read_b64_tr_b16 v[56:57], v86 offset:8192
  ds_read_b64_tr_b16 v[58:59], v87 offset:8192
  v_mfma_f32_4x4x4_16b_bf16 v[64:67], v[74:75], v[60:61], v[64:67]
  v_mfma_f32_4x4x4_16b_bf16 v[120:123], v[74:75], v[62:63], v[120:123]
  s_waitcnt vmcnt(3)
  s_barrier
  s_waitcnt lgkmcnt(5)
  v_mfma_f32_32x32x16_bf16 v[0:15], v[44:47], v[36:39], v[0:15]
  ds_read_b128 v[32:35], v112 offset:0
  ds_read_b64_tr_b16 v[60:61], v80 offset:16384
  ds_read_b64_tr_b16 v[62:63], v81 offset:16384
  s_add_u32 m0, s39, 49152
  s_add_u32 s40, s38, s63
  buffer_load_dwordx4 v79, s[12:15], s40 offen lds
  s_add_u32 s63, s63, 110592
  v_mfma_f32_32x32x16_bf16 v[16:31], v[48:51], v[36:39], v[16:31]
  ds_read_b64_tr_b16 v[44:45], v82 offset:16384
  ds_read_b64_tr_b16 v[46:47], v83 offset:16384
  s_waitcnt lgkmcnt(5)
  v_mfma_f32_32x32x16_bf16 v[0:15], v[52:55], v[40:43], v[0:15]
  ds_read_b128 v[36:39], v114 offset:0
  ds_read_b64_tr_b16 v[48:49], v84 offset:16384
  ds_read_b64_tr_b16 v[50:51], v85 offset:16384
  v_mfma_f32_4x4x4_16b_bf16 v[64:67], v[72:73], v[52:53], v[64:67]
  v_mfma_f32_4x4x4_16b_bf16 v[120:123], v[72:73], v[54:55], v[120:123]
  v_mfma_f32_32x32x16_bf16 v[16:31], v[56:59], v[40:43], v[16:31]
  ds_read_b64_tr_b16 v[52:53], v86 offset:16384
  ds_read_b64_tr_b16 v[54:55], v87 offset:16384
  v_mfma_f32_4x4x4_16b_bf16 v[64:67], v[74:75], v[56:57], v[64:67]
  v_mfma_f32_4x4x4_16b_bf16 v[120:123], v[74:75], v[58:59], v[120:123]
  s_waitcnt vmcnt(3)
  s_barrier
  s_waitcnt lgkmcnt(5)
  v_mfma_f32_32x32x16_bf16 v[0:15], v[60:63], v[32:35], v[0:15]
  ds_read_b128 v[40:43], v116 offset:0
  ds_read_b64_tr_b16 v[56:57], v80 offset:24576
  ds_read_b64_tr_b16 v[58:59], v81 offset:24576
  s_add_u32 m0, s39, 57344
  s_add_u32 s40, s38, s63
  buffer_load_dwordx4 v79, s[12:15], s40 offen lds
  s_add_u32 s63, s63, 110592
  s_cmp_eq_u32 s63, 2211840
  s_cselect_b32 s63, 0, s63
  v_mfma_f32_32x32x16_bf16 v[16:31], v[44:47], v[32:35], v[16:31]
  ds_read_b64_tr_b16 v[60:61], v82 offset:24576
  ds_read_b64_tr_b16 v[62:63], v83 offset:24576
  s_add_u32 m0, s37, 32768
  s_add_u32 s40, s36, s62
  buffer_load_dwordx4 v78, s[8:11], s40 offen lds
  s_waitcnt lgkmcnt(5)
  v_mfma_f32_32x32x16_bf16 v[0:15], v[48:51], v[36:39], v[0:15]
  ds_read_b128 v[32:35], v118 offset:0
  ds_read_b64_tr_b16 v[44:45], v84 offset:24576
  ds_read_b64_tr_b16 v[46:47], v85 offset:24576
  s_add_u32 m0, s37, 33792
  s_add_u32 s40, s36, s62
  s_add_u32 s40, s40, 10240
  buffer_load_dwordx4 v105, s[8:11], s40 offen lds
  s_add_u32 s62, s62, 128
  s_cmp_eq_u32 s62, 1280
  s_cselect_b32 s62, 0, s62
  v_mfma_f32_4x4x4_16b_bf16 v[64:67], v[72:73], v[48:49], v[64:67]
  v_mfma_f32_4x4x4_16b_bf16 v[120:123], v[72:73], v[50:51], v[120:123]
  v_mfma_f32_32x32x16_bf16 v[16:31], v[52:55], v[36:39], v[16:31]
  ds_read_b64_tr_b16 v[48:49], v86 offset:24576
  ds_read_b64_tr_b16 v[50:51], v87 offset:24576
  v_mfma_f32_4x4x4_16b_bf16 v[64:67], v[74:75], v[52:53], v[64:67]
  v_mfma_f32_4x4x4_16b_bf16 v[120:123], v[74:75], v[54:55], v[120:123]
  s_waitcnt vmcnt(3)
  s_barrier
  s_waitcnt lgkmcnt(5)
  v_mfma_f32_32x32x16_bf16 v[0:15], v[56:59], v[40:43], v[0:15]
  ds_read_b128 v[36:39], v112 offset:16384
  ds_read_b64_tr_b16 v[52:53], v80 offset:0
  ds_read_b64_tr_b16 v[54:55], v81 offset:0
  s_add_u32 m0, s39, 65536
  s_add_u32 s40, s38, s63
  buffer_load_dwordx4 v79, s[12:15], s40 offen lds
  s_add_u32 s63, s63, 110592
  v_mfma_f32_32x32x16_bf16 v[16:31], v[60:63], v[40:43], v[16:31]
  ds_read_b64_tr_b16 v[56:57], v82 offset:0
  ds_read_b64_tr_b16 v[58:59], v83 offset:0
  s_waitcnt lgkmcnt(5)
  v_mfma_f32_32x32x16_bf16 v[0:15], v[44:47], v[32:35], v[0:15]
  ds_read_b128 v[40:43], v114 offset:16384
  ds_read_b64_tr_b16 v[60:61], v84 offset:0
  ds_read_b64_tr_b16 v[62:63], v85 offset:0
  v_mfma_f32_4x4x4_16b_bf16 v[64:67], v[72:73], v[44:45], v[64:67]
  v_mfma_f32_4x4x4_16b_bf16 v[120:123], v[72:73], v[46:47], v[120:123]
  v_mfma_f32_32x32x16_bf16 v[16:31], v[48:51], v[32:35], v[16:31]
  ds_read_b64_tr_b16 v[44:45], v86 offset:0
  ds_read_b64_tr_b16 v[46:47], v87 offset:0
  v_mfma_f32_4x4x4_16b_bf16 v[64:67], v[74:75], v[48:49], v[64:67]
  v_mfma_f32_4x4x4_16b_bf16 v[120:123], v[74:75], v[50:51], v[120:123]
  s_waitcnt vmcnt(3)
  s_barrier
  s_waitcnt lgkmcnt(5)
  v_mfma_f32_32x32x16_bf16 v[0:15], v[52:55], v[36:39], v[0:15]
  ds_read_b128 v[32:35], v116 offset:16384
  ds_read_b64_tr_b16 v[48:49], v80 offset:8192
  ds_read_b64_tr_b16 v[50:51], v81 offset:8192
  s_add_u32 m0, s39, 73728
  s_add_u32 s40, s38, s63
  buffer_load_dwordx4 v79, s[12:15], s40 offen lds
  s_add_u32 s63, s63, 110592
  s_cmp_eq_u32 s63, 2211840
  s_cselect_b32 s63, 0, s63
  v_mfma_f32_32x32x16_bf16 v[16:31], v[56:59], v[36:39], v[16:31]
  ds_read_b64_tr_b16 v[52:53], v82 offset:8192
  ds_read_b64_tr_b16 v[54:55], v83 offset:8192
  s_add_u32 m0, s37, 0
  s_add_u32 s40, s36, s62
  buffer_load_dwordx4 v78, s[8:11], s40 offen lds
  s_waitcnt lgkmcnt(5)
  v_mfma_f32_32x32x16_bf16 v[0:15], v[60:63], v[40:43], v[0:15]
  ds_read_b128 v[36:39], v118 offset:16384
  ds_read_b64_tr_b16 v[56:57], v84 offset:8192
  ds_read_b64_tr_b16 v[58:59], v85 offset:8192
  s_add_u32 m0, s37, 1024
  s_add_u32 s40, s36, s62
  s_add_u32 s40, s40, 10240
  buffer_load_dwordx4 v105, s[8:11], s40 offen lds
  s_add_u32 s62, s62, 128
  s_cmp_eq_u32 s62, 1280
  s_cselect_b32 s62, 0, s62
  v_mfma_f32_4x4x4_16b_bf16 v[64:67], v[72:73], v[60:61], v[64:67]
  v_mfma_f32_4x4x4_16b_bf16 v[120:123], v[72:73], v[62:63], v[120:123]
  v_mfma_f32_32x32x16_bf16 v[16:31], v[44:47], v[40:43], v[16:31]
  ds_read_b64_tr_b16 v[60:61], v86 offset:8192
  ds_read_b64_tr_b16 v[62:63], v87 offset:8192
  v_mfma_f32_4x4x4_16b_bf16 v[64:67], v[74:75], v[44:45], v[64:67]
  v_mfma_f32_4x4x4_16b_bf16 v[120:123], v[74:75], v[46:47], v[120:123]
  s_waitcnt vmcnt(3)
  s_barrier
  s_waitcnt lgkmcnt(5)
  v_mfma_f32_32x32x16_bf16 v[0:15], v[48:51], v[32:35], v[0:15]
  ds_read_b128 v[40:43], v112 offset:32768
  ds_read_b64_tr_b16 v[44:45], v80 offset:16384
  ds_read_b64_tr_b16 v[46:47], v81 offset:16384
  s_add_u32 m0, s39, 49152
  s_add_u32 s40, s38, s63
  buffer_load_dwordx4 v79, s[12:15], s40 offen lds
  s_add_u32 s63, s63, 110592
  v_mfma_f32_32x32x16_bf16 v[16:31], v[52:55], v[32:35], v[16:31]
  ds_read_b64_tr_b16 v[48:49], v82 offset:16384
  ds_read_b64_tr_b16 v[50:51], v83 offset:16384
  s_waitcnt lgkmcnt(5)
  v_mfma_f32_32x32x16_bf16 v[0:15], v[56:59], v[36:39], v[0:15]
  ds_read_b128 v[32:35], v114 offset:32768
  ds_read_b64_tr_b16 v[52:53], v84 offset:16384
  ds_read_b64_tr_b16 v[54:55], v85 offset:16384
  v_mfma_f32_4x4x4_16b_bf16 v[64:67], v[72:73], v[56:57], v[64:67]
  v_mfma_f32_4x4x4_16b_bf16 v[120:123], v[72:73], v[58:59], v[120:123]
  v_mfma_f32_32x32x16_bf16 v[16:31], v[60:63], v[36:39], v[16:31]
  ds_read_b64_tr_b16 v[56:57], v86 offset:16384
  ds_read_b64_tr_b16 v[58:59], v87 offset:16384
  v_mfma_f32_4x4x4_16b_bf16 v[64:67], v[74:75], v[60:61], v[64:67]
  v_mfma_f32_4x4x4_16b_bf16 v[120:123], v[74:75], v[62:63], v[120:123]
  s_waitcnt vmcnt(3)
  s_barrier
  s_waitcnt lgkmcnt(5)
  v_mfma_f32_32x32x16_bf16 v[0:15], v[44:47], v[40:43], v[0:15]
  ds_read_b128 v[36:39], v116 offset:32768
  ds_read_b64_tr_b16 v[60:61], v80 offset:24576
  ds_read_b64_tr_b16 v[62:63], v81 offset:24576
  s_add_u32 m0, s39, 57344
  s_add_u32 s40, s38, s63
  buffer_load_dwordx4 v79, s[12:15], s40 offen lds
  s_add_u32 s63, s63, 110592
  s_cmp_eq_u32 s63, 2211840
  s_cselect_b32 s63, 0, s63
  v_mfma_f32_32x32x16_bf16 v[16:31], v[48:51], v[40:43], v[16:31]
  ds_read_b64_tr_b16 v[44:45], v82 offset:24576
  ds_read_b64_tr_b16 v[46:47], v83 offset:24576
  s_add_u32 m0, s37, 16384
  s_add_u32 s40, s36, s62
  buffer_load_dwordx4 v78, s[8:11], s40 offen lds
  s_waitcnt lgkmcnt(5)
  v_mfma_f32_32x32x16_bf16 v[0:15], v[52:55], v[32:35], v[0:15]
  ds_read_b128 v[40:43], v118 offset:32768
  ds_read_b64_tr_b16 v[48:49], v84 offset:24576
  ds_read_b64_tr_b16 v[50:51], v85 offset:24576
  s_add_u32 m0, s37, 17408
  s_add_u32 s40, s36, s62
  s_add_u32 s40, s40, 10240
  buffer_load_dwordx4 v105, s[8:11], s40 offen lds
  s_add_u32 s62, s62, 128
  s_cmp_eq_u32 s62, 1280
  s_cselect_b32 s62, 0, s62
  v_mfma_f32_4x4x4_16b_bf16 v[64:67], v[72:73], v[52:53], v[64:67]
  v_mfma_f32_4x4x4_16b_bf16 v[120:123], v[72:73], v[54:55], v[120:123]
  v_mfma_f32_32x32x16_bf16 v[16:31], v[56:59], v[32:35], v[16:31]
  ds_read_b64_tr_b16 v[52:53], v86 offset:24576
  ds_read_b64_tr_b16 v[54:55], v87 offset:24576
  v_mfma_f32_4x4x4_16b_bf16 v[64:67], v[74:75], v[56:57], v[64:67]
  v_mfma_f32_4x4x4_16b_bf16 v[120:123], v[74:75], v[58:59], v[120:123]
  s_waitcnt vmcnt(3)
  s_barrier
  s_waitcnt lgkmcnt(5)
  v_mfma_f32_32x32x16_bf16 v[0:15], v[60:63], v[36:39], v[0:15]
  ds_read_b128 v[32:35], v112 offset:0
  ds_read_b64_tr_b16 v[56:57], v80 offset:0
  ds_read_b64_tr_b16 v[58:59], v81 offset:0
  s_add_u32 m0, s39, 65536
  s_add_u32 s40, s38, s63
  buffer_load_dwordx4 v79, s[12:15], s40 offen lds
  s_add_u32 s63, s63, 110592
  v_mfma_f32_32x32x16_bf16 v[16:31], v[44:47], v[36:39], v[16:31]
  ds_read_b64_tr_b16 v[60:61], v82 offset:0
  ds_read_b64_tr_b16 v[62:63], v83 offset:0
  s_waitcnt lgkmcnt(5)
  v_mfma_f32_32x32x16_bf16 v[0:15], v[48:51], v[40:43], v[0:15]
  ds_read_b128 v[36:39], v114 offset:0
  ds_read_b64_tr_b16 v[44:45], v84 offset:0
  ds_read_b64_tr_b16 v[46:47], v85 offset:0
  v_mfma_f32_4x4x4_16b_bf16 v[64:67], v[72:73], v[48:49], v[64:67]
  v_mfma_f32_4x4x4_16b_bf16 v[120:123], v[72:73], v[50:51], v[120:123]
  v_mfma_f32_32x32x16_bf16 v[16:31], v[52:55], v[40:43], v[16:31]
  ds_read_b64_tr_b16 v[48:49], v86 offset:0
  ds_read_b64_tr_b16 v[50:51], v87 offset:0
  v_mfma_f32_4x4x4_16b_bf16 v[64:67], v[74:75], v[52:53], v[64:67]
  v_mfma_f32_4x4x4_16b_bf16 v[120:123], v[74:75], v[54:55], v[120:123]
  s_waitcnt vmcnt(3)
  s_barrier
  s_waitcnt lgkmcnt(5)
  v_mfma_f32_32x32x16_bf16 v[0:15], v[56:59], v[32:35], v[0:15]
  ds_read_b128 v[40:43], v116 offset:0
  ds_read_b64_tr_b16 v[52:53], v80 offset:8192
  ds_read_b64_tr_b16 v[54:55], v81 offset:8192
  s_add_u32 m0, s39, 73728
  s_add_u32 s40, s38, s63
  buffer_load_dwordx4 v79, s[12:15], s40 offen lds
  s_add_u32 s63, s63, 110592
  s_cmp_eq_u32 s63, 2211840
  s_cselect_b32 s63, 0, s63
  v_mfma_f32_32x32x16_bf16 v[16:31], v[60:63], v[32:35], v[16:31]
  ds_read_b64_tr_b16 v[56:57], v82 offset:8192
  ds_read_b64_tr_b16 v[58:59], v83 offset:8192
  s_add_u32 m0, s37, 32768
  s_add_u32 s40, s36, s62
  buffer_load_dwordx4 v78, s[8:11], s40 offen lds
  s_waitcnt lgkmcnt(5)
  v_mfma_f32_32x32x16_bf16 v[0:15], v[44:47], v[36:39], v[0:15]
  ds_read_b128 v[32:35], v118 offset:0
  ds_read_b64_tr_b16 v[60:61], v84 offset:8192
  ds_read_b64_tr_b16 v[62:63], v85 offset:8192
  s_add_u32 m0, s37, 33792
  s_add_u32 s40, s36, s62
  s_add_u32 s40, s40, 10240
  buffer_load_dwordx4 v105, s[8:11], s40 offen lds
  s_add_u32 s62, s62, 128
  s_cmp_eq_u32 s62, 1280
  s_cselect_b32 s62, 0, s62
  v_mfma_f32_4x4x4_16b_bf16 v[64:67], v[72:73], v[44:45], v[64:67]
  v_mfma_f32_4x4x4_16b_bf16 v[120:123], v[72:73], v[46:47], v[120:123]
  v_mfma_f32_32x32x16_bf16 v[16:31], v[48:51], v[36:39], v[16:31]
  ds_read_b64_tr_b16 v[44:45], v86 offset:8192
  ds_read_b64_tr_b16 v[46:47], v87 offset:8192
  v_mfma_f32_4x4x4_16b_bf16 v[64:67], v[74:75], v[48:49], v[64:67]
  v_mfma_f32_4x4x4_16b_bf16 v[120:123], v[74:75], v[50:51], v[120:123]
  s_waitcnt vmcnt(3)
  s_barrier
  s_waitcnt lgkmcnt(5)
  v_mfma_f32_32x32x16_bf16 v[0:15], v[52:55], v[40:43], v[0:15]
  ds_read_b128 v[36:39], v112 offset:16384
  ds_read_b64_tr_b16 v[48:49], v80 offset:16384
  ds_read_b64_tr_b16 v[50:51], v81 offset:16384
  s_add_u32 m0, s39, 49152
  s_add_u32 s40, s38, s63
  buffer_load_dwordx4 v79, s[12:15], s40 offen lds
  s_add_u32 s63, s63, 110592
  v_mfma_f32_32x32x16_bf16 v[16:31], v[56:59], v[40:43], v[16:31]
  ds_read_b64_tr_b16 v[52:53], v82 offset:16384
  ds_read_b64_tr_b16 v[54:55], v83 offset:16384
  s_mov_b64 exec, 1
  buffer_load_dword v68, v69, s[52:55], s50 offen sc1
  s_mov_b64 exec, -1
  s_waitcnt lgkmcnt(5)
  v_mfma_f32_32x32x16_bf16 v[0:15], v[60:63], v[32:35], v[0:15]
  ds_read_b128 v[40:43], v114 offset:16384
  ds_read_b64_tr_b16 v[56:57], v84 offset:16384
  ds_read_b64_tr_b16 v[58:59], v85 offset:16384
  v_mfma_f32_4x4x4_16b_bf16 v[64:67], v[72:73], v[60:61], v[64:67]
  v_mfma_f32_4x4x4_16b_bf16 v[120:123], v[72:73], v[62:63], v[120:123]
  v_mfma_f32_32x32x16_bf16 v[16:31], v[44:47], v[32:35], v[16:31]
  ds_read_b64_tr_b16 v[60:61], v86 offset:16384
  ds_read_b64_tr_b16 v[62:63], v87 offset:16384
  v_mfma_f32_4x4x4_16b_bf16 v[64:67], v[74:75], v[44:45], v[64:67]
  v_mfma_f32_4x4x4_16b_bf16 v[120:123], v[74:75], v[46:47], v[120:123]
  s_waitcnt vmcnt(4)
  s_barrier
  s_waitcnt lgkmcnt(5)
  v_mfma_f32_32x32x16_bf16 v[0:15], v[48:51], v[36:39], v[0:15]
  ds_read_b128 v[32:35], v116 offset:16384
  ds_read_b64_tr_b16 v[44:45], v80 offset:24576
  ds_read_b64_tr_b16 v[46:47], v81 offset:24576
  s_add_u32 m0, s39, 57344
  s_add_u32 s40, s38, s63
  buffer_load_dwordx4 v79, s[12:15], s40 offen lds
  s_add_u32 s63, s63, 110592
  s_cmp_eq_u32 s63, 2211840
  s_cselect_b32 s63, 0, s63
  v_mfma_f32_32x32x16_bf16 v[16:31], v[52:55], v[36:39], v[16:31]
  ds_read_b64_tr_b16 v[48:49], v82 offset:24576
  ds_read_b64_tr_b16 v[50:51], v83 offset:24576
  s_add_u32 m0, s37, 0
  s_add_u32 s40, s36, s62
  buffer_load_dwordx4 v78, s[8:11], s40 offen lds
  s_waitcnt lgkmcnt(5)
  v_mfma_f32_32x32x16_bf16 v[0:15], v[56:59], v[40:43], v[0:15]
  ds_read_b128 v[36:39], v118 offset:16384
  ds_read_b64_tr_b16 v[52:53], v84 offset:24576
  ds_read_b64_tr_b16 v[54:55], v85 offset:24576
  s_add_u32 m0, s37, 1024
  s_add_u32 s40, s36, s62
  s_add_u32 s40, s40, 10240
  buffer_load_dwordx4 v105, s[8:11], s40 offen lds
  s_add_u32 s62, s62, 128
  s_cmp_eq_u32 s62, 1280
  s_cselect_b32 s62, 0, s62
  v_mfma_f32_4x4x4_16b_bf16 v[64:67], v[72:73], v[56:57], v[64:67]
  v_mfma_f32_4x4x4_16b_bf16 v[120:123], v[72:73], v[58:59], v[120:123]
  v_mfma_f32_32x32x16_bf16 v[16:31], v[60:63], v[40:43], v[16:31]
  ds_read_b64_tr_b16 v[56:57], v86 offset:24576
  ds_read_b64_tr_b16 v[58:59], v87 offset:24576
  v_mfma_f32_4x4x4_16b_bf16 v[64:67], v[74:75], v[60:61], v[64:67]
  v_mfma_f32_4x4x4_16b_bf16 v[120:123], v[74:75], v[62:63], v[120:123]
  s_waitcnt vmcnt(4)
  s_barrier
  s_waitcnt lgkmcnt(5)
  v_mfma_f32_32x32x16_bf16 v[0:15], v[44:47], v[32:35], v[0:15]
  ds_read_b128 v[40:43], v112 offset:32768
  ds_read_b64_tr_b16 v[60:61], v80 offset:0
  ds_read_b64_tr_b16 v[62:63], v81 offset:0
  s_add_u32 m0, s39, 65536
  s_add_u32 s40, s38, s63
  buffer_load_dwordx4 v79, s[12:15], s40 offen lds
  s_add_u32 s63, s63, 110592
  v_mfma_f32_32x32x16_bf16 v[16:31], v[48:51], v[32:35], v[16:31]
  ds_read_b64_tr_b16 v[44:45], v82 offset:0
  ds_read_b64_tr_b16 v[46:47], v83 offset:0
  s_waitcnt lgkmcnt(5)
  v_mfma_f32_32x32x16_bf16 v[0:15], v[52:55], v[36:39], v[0:15]
  ds_read_b128 v[32:35], v114 offset:32768
  ds_read_b64_tr_b16 v[48:49], v84 offset:0
  ds_read_b64_tr_b16 v[50:51], v85 offset:0
  v_mfma_f32_4x4x4_16b_bf16 v[64:67], v[72:73], v[52:53], v[64:67]
  v_mfma_f32_4x4x4_16b_bf16 v[120:123], v[72:73], v[54:55], v[120:123]
  v_mfma_f32_32x32x16_bf16 v[16:31], v[56:59], v[36:39], v[16:31]
  ds_read_b64_tr_b16 v[52:53], v86 offset:0
  ds_read_b64_tr_b16 v[54:55], v87 offset:0
  v_mfma_f32_4x4x4_16b_bf16 v[64:67], v[74:75], v[56:57], v[64:67]
  v_mfma_f32_4x4x4_16b_bf16 v[120:123], v[74:75], v[58:59], v[120:123]
  s_waitcnt vmcnt(3)
  s_barrier
  s_waitcnt lgkmcnt(5)
  v_mfma_f32_32x32x16_bf16 v[0:15], v[60:63], v[40:43], v[0:15]
  ds_read_b128 v[36:39], v116 offset:32768
  ds_read_b64_tr_b16 v[56:57], v80 offset:8192
  ds_read_b64_tr_b16 v[58:59], v81 offset:8192
  s_add_u32 m0, s39, 73728
  s_add_u32 s40, s38, s63
  buffer_load_dwordx4 v79, s[12:15], s40 offen lds
  s_add_u32 s63, s63, 110592
  s_cmp_eq_u32 s63, 2211840
  s_cselect_b32 s63, 0, s63
  v_mfma_f32_32x32x16_bf16 v[16:31], v[44:47], v[40:43], v[16:31]
  ds_read_b64_tr_b16 v[60:61], v82 offset:8192
  ds_read_b64_tr_b16 v[62:63], v83 offset:8192
  v_readfirstlane_b32 s60, v68
  s_nop 0
  s_cmp_eq_u32 s60, 1
  s_cbranch_scc0 g1_spin
g1_spun:
  buffer_load_dwordx2 v[76:77], v70, s[56:59], s51 offen sc1
  s_waitcnt lgkmcnt(5)
  v_mfma_f32_32x32x16_bf16 v[0:15], v[48:51], v[32:35], v[0:15]
  ds_read_b128 v[40:43], v118 offset:32768
  ds_read_b64_tr_b16 v[44:45], v84 offset:8192
  ds_read_b64_tr_b16 v[46:47], v85 offset:8192
  buffer_load_ushort v88, v111, s[20:23], s41 offen
  v_mfma_f32_4x4x4_16b_bf16 v[64:67], v[72:73], v[48:49], v[64:67]
  v_mfma_f32_4x4x4_16b_bf16 v[120:123], v[72:73], v[50:51], v[120:123]
  v_mfma_f32_32x32x16_bf16 v[16:31], v[52:55], v[32:35], v[16:31]
  ds_read_b64_tr_b16 v[48:49], v86 offset:8192
  ds_read_b64_tr_b16 v[50:51], v87 offset:8192
  v_mfma_f32_4x4x4_16b_bf16 v[64:67], v[74:75], v[52:53], v[64:67]
  v_mfma_f32_4x4x4_16b_bf16 v[120:123], v[74:75], v[54:55], v[120:123]
  s_waitcnt vmcnt(3)
  s_barrier
  s_waitcnt lgkmcnt(5)
  v_mfma_f32_32x32x16_bf16 v[0:15], v[56:59], v[36:39], v[0:15]
  ds_read_b128 v[32:35], v112 offset:0
  ds_read_b64_tr_b16 v[52:53], v80 offset:16384
  ds_read_b64_tr_b16 v[54:55], v81 offset:16384
  v_mfma_f32_32x32x16_bf16 v[16:31], v[60:63], v[36:39], v[16:31]
  ds_read_b64_tr_b16 v[56:57], v82 offset:16384
  ds_read_b64_tr_b16 v[58:59], v83 offset:16384
  s_waitcnt lgkmcnt(5)
  v_mfma_f32_32x32x16_bf16 v[0:15], v[44:47], v[40:43], v[0:15]
  ds_read_b128 v[36:39], v114 offset:0
  ds_read_b64_tr_b16 v[60:61], v84 offset:16384
  ds_read_b64_tr_b16 v[62:63], v85 offset:16384
  v_mfma_f32_4x4x4_16b_bf16 v[64:67], v[72:73], v[44:45], v[64:67]
  v_mfma_f32_4x4x4_16b_bf16 v[120:123], v[72:73], v[46:47], v[120:123]
  v_mfma_f32_32x32x16_bf16 v[16:31], v[48:51], v[40:43], v[16:31]
  ds_read_b64_tr_b16 v[44:45], v86 offset:16384
  ds_read_b64_tr_b16 v[46:47], v87 offset:16384
  v_mfma_f32_4x4x4_16b_bf16 v[64:67], v[74:75], v[48:49], v[64:67]
  v_mfma_f32_4x4x4_16b_bf16 v[120:123], v[74:75], v[50:51], v[120:123]
  s_waitcnt vmcnt(2)
  s_barrier
  s_waitcnt lgkmcnt(5)
  v_mfma_f32_32x32x16_bf16 v[0:15], v[52:55], v[32:35], v[0:15]
  ds_read_b128 v[40:43], v116 offset:0
  ds_read_b64_tr_b16 v[48:49], v80 offset:24576
  ds_read_b64_tr_b16 v[50:51], v81 offset:24576
  v_mfma_f32_32x32x16_bf16 v[16:31], v[56:59], v[32:35], v[16:31]
  ds_read_b64_tr_b16 v[52:53], v82 offset:24576
  ds_read_b64_tr_b16 v[54:55], v83 offset:24576
  s_waitcnt lgkmcnt(5)
  v_mfma_f32_32x32x16_bf16 v[0:15], v[60:63], v[36:39], v[0:15]
  ds_read_b128 v[32:35], v118 offset:0
  ds_read_b64_tr_b16 v[56:57], v84 offset:24576
  ds_read_b64_tr_b16 v[58:59], v85 offset:24576
  v_mfma_f32_4x4x4_16b_bf16 v[64:67], v[72:73], v[60:61], v[64:67]
  v_mfma_f32_4x4x4_16b_bf16 v[120:123], v[72:73], v[62:63], v[120:123]
  v_mfma_f32_32x32x16_bf16 v[16:31], v[44:47], v[36:39], v[16:31]
  ds_read_b64_tr_b16 v[60:61], v86 offset:24576
  ds_read_b64_tr_b16 v[62:63], v87 offset:24576
  v_mfma_f32_4x4x4_16b_bf16 v[64:67], v[74:75], v[44:45], v[64:67]
  v_mfma_f32_4x4x4_16b_bf16 v[120:123], v[74:75], v[46:47], v[120:123]
  s_waitcnt lgkmcnt(5)
  v_mfma_f32_32x32x16_bf16 v[0:15], v[48:51], v[40:43], v[0:15]
  v_mfma_f32_32x32x16_bf16 v[16:31], v[52:55], v[40:43], v[16:31]
  s_waitcnt lgkmcnt(0)
  v_mfma_f32_32x32x16_bf16 v[0:15], v[56:59], v[32:35], v[0:15]
  v_mfma_f32_4x4x4_16b_bf16 v[64:67], v[72:73], v[56:57], v[64:67]
  v_mfma_f32_4x4x4_16b_bf16 v[120:123], v[72:73], v[58:59], v[120:123]
  v_mfma_f32_32x32x16_bf16 v[16:31], v[60:63], v[32:35], v[16:31]
  v_mfma_f32_4x4x4_16b_bf16 v[64:67], v[74:75], v[60:61], v[64:67]
  v_mfma_f32_4x4x4_16b_bf16 v[120:123], v[74:75], v[62:63], v[120:123]
  s_setprio 3
  s_nop 3
  v_add_f32 v64, v64, v120
  v_add_f32 v65, v65, v121
  s_nop 1
  v_permlane32_swap_b32 v64, v65
  v_add_f32 v64, v64, v65
  v_lshlrev_b32 v32, 2, v104
  s_lshl_b32 s46, s31, 8
  v_add_u32 v33, s46, v32
  ds_write_b32 v33, v64 offset:18432
  s_lshl_b32 s46, s33, 10
  v_add_u32 v35, s46, v32
  v_lshrrev_b32 v36, 5, v104
  v_lshlrev_b32 v37, 8, v36
  v_lshlrev_b32 v36, 4, v36
  s_lshl_b32 s46, s31, 8
  v_add_u32 v36, s46, v36
  v_and_b32 v38, 15, v104
  v_lshl_add_u32 v37, v38, 4, v37
  v_lshrrev_b32 v38, 4, v104
  v_and_b32 v38, 1, v38
  v_mul_u32_u24 v38, 55296, v38
  v_add_u32 v37, v37, v38
  v_mov_b32 v38, 0x3f317218
  s_lshl_b32 s41, s29, 2
  s_add_u32 s41, s41, s32
  s_mul_i32 s41, s41, 108
  s_lshl_b32 s42, s30, 2
  s_add_u32 s41, s41, s42
  s_lshl_b32 s42, s33, 1
  s_add_u32 s41, s41, s42
  s_lshl_b32 s41, s41, 10
  s_mov_b32 s42, 0xbfb17218
  s_waitcnt lgkmcnt(0)
  s_barrier
  s_cmp_eq_u32 s30, 13
  s_cselect_b32 s46, s33, 0
  s_cmp_lg_u32 s46, 0
  s_cbranch_scc1 g1_done
  ds_read2st64_b32 v[44:45], v35 offset0:72 offset1:73
  ds_read2st64_b32 v[46:47], v35 offset0:74 offset1:75
  s_waitcnt lgkmcnt(0)
  v_add_f32 v44, v44, v45
  v_add_f32 v46, v46, v47
  v_add_f32 v44, v44, v46
  ds_write_b32 v33, v44 offset:20480
  s_waitcnt vmcnt(0)
  v_lshlrev_b32 v88, 16, v88
  v_mul_f32 v88, 0x3fb8aa3b, v88
  ds_write_b32 v33, v88 offset:22528
  v_mov_b32 v109, v76
  v_mov_b32 v110, v77
  s_mov_b32 s43, 0x3fb8aa3b
  ds_read_b128 v[64:67], v36 offset:22528
  ds_read_b128 v[68:71], v36 offset:22560
  ds_read_b128 v[72:75], v36 offset:22592
  ds_read_b128 v[76:79], v36 offset:22624
  ds_read_b128 v[88:91], v36 offset:22656
  ds_read_b128 v[92:95], v36 offset:22688
  ds_read_b128 v[96:99], v36 offset:22720
  ds_read_b128 v[100:103], v36 offset:22752
  ds_read_b128 v[112:115], v36 offset:20480
  ds_read_b128 v[116:119], v36 offset:20512
  ds_read_b128 v[120:123], v36 offset:20544
  ds_read_b128 v[124:127], v36 offset:20576
  s_waitcnt lgkmcnt(8)
  v_fmac_f32 v64, v0, v110
  v_fmac_f32 v65, v1, v110
  v_fmac_f32 v66, v2, v110
  v_fmac_f32 v67, v3, v110
  v_fmac_f32 v68, v4, v110
  v_fmac_f32 v69, v5, v110
  v_fmac_f32 v70, v6, v110
  v_fmac_f32 v71, v7, v110
  v_fmac_f32 v72, v8, v110
  v_fmac_f32 v73, v9, v110
  v_fmac_f32 v74, v10, v110
  v_fmac_f32 v75, v11, v110
  v_fmac_f32 v76, v12, v110
  v_fmac_f32 v77, v13, v110
  v_fmac_f32 v78, v14, v110
  v_fmac_f32 v79, v15, v110
  s_waitcnt lgkmcnt(3)
  v_fmac_f32 v64, v112, v109
  v_fmac_f32 v65, v113, v109
  v_fmac_f32 v66, v114, v109
  v_fmac_f32 v67, v115, v109
  s_waitcnt lgkmcnt(2)
  v_fmac_f32 v68, v116, v109
  v_fmac_f32 v69, v117, v109
  v_fmac_f32 v70, v118, v109
  v_fmac_f32 v71, v119, v109
  s_waitcnt lgkmcnt(1)
  v_fmac_f32 v72, v120, v109
  v_fmac_f32 v73, v121, v109
  v_fmac_f32 v74, v122, v109
  v_fmac_f32 v75, v123, v109
  s_waitcnt lgkmcnt(0)
  v_fmac_f32 v76, v124, v109
  v_fmac_f32 v77, v125, v109
  v_fmac_f32 v78, v126, v109
  v_fmac_f32 v79, v127, v109
  v_exp_f32 v40, v64
  v_exp_f32 v41, v65
  v_exp_f32 v42, v66
  v_exp_f32 v43, v67
  v_exp_f32 v44, v68
  v_exp_f32 v45, v69
  v_exp_f32 v46, v70
  v_exp_f32 v47, v71
  v_exp_f32 v48, v72
  v_exp_f32 v49, v73
  v_exp_f32 v50, v74
  v_exp_f32 v51, v75
  v_exp_f32 v52, v76
  v_exp_f32 v53, v77
  v_exp_f32 v54, v78
  v_exp_f32 v55, v79
  v_add_f32 v40, 1.0, v40
  v_add_f32 v41, 1.0, v41
  v_add_f32 v42, 1.0, v42
  v_add_f32 v43, 1.0, v43
  v_add_f32 v44, 1.0, v44
  v_add_f32 v45, 1.0, v45
  v_add_f32 v46, 1.0, v46
  v_add_f32 v47, 1.0, v47
  v_add_f32 v48, 1.0, v48
  v_add_f32 v49, 1.0, v49
  v_add_f32 v50, 1.0, v50
  v_add_f32 v51, 1.0, v51
  v_add_f32 v52, 1.0, v52
  v_add_f32 v53, 1.0, v53
  v_add_f32 v54, 1.0, v54
  v_add_f32 v55, 1.0, v55
  v_fma_f32 v40, v40, v40, 1.0
  v_fma_f32 v41, v41, v41, 1.0
  v_fma_f32 v42, v42, v42, 1.0
  v_fma_f32 v43, v43, v43, 1.0
  v_fma_f32 v44, v44, v44, 1.0
  v_fma_f32 v45, v45, v45, 1.0
  v_fma_f32 v46, v46, v46, 1.0
  v_fma_f32 v47, v47, v47, 1.0
  v_fma_f32 v48, v48, v48, 1.0
  v_fma_f32 v49, v49, v49, 1.0
  v_fma_f32 v50, v50, v50, 1.0
  v_fma_f32 v51, v51, v51, 1.0
  v_fma_f32 v52, v52, v52, 1.0
  v_fma_f32 v53, v53, v53, 1.0
  v_fma_f32 v54, v54, v54, 1.0
  v_fma_f32 v55, v55, v55, 1.0
  v_rcp_f32 v40, v40
  v_rcp_f32 v41, v41
  v_rcp_f32 v42, v42
  v_rcp_f32 v43, v43
  v_rcp_f32 v44, v44
  v_rcp_f32 v45, v45
  v_rcp_f32 v46, v46
  v_rcp_f32 v47, v47
  v_rcp_f32 v48, v48
  v_rcp_f32 v49, v49
  v_rcp_f32 v50, v50
  v_rcp_f32 v51, v51
  v_rcp_f32 v52, v52
  v_rcp_f32 v53, v53
  v_rcp_f32 v54, v54
  v_rcp_f32 v55, v55
  v_fma_f32 v40, v40, s42, v38
  v_fma_f32 v41, v41, s42, v38
  v_fma_f32 v42, v42, s42, v38
  v_fma_f32 v43, v43, s42, v38
  v_fma_f32 v44, v44, s42, v38
  v_fma_f32 v45, v45, s42, v38
  v_fma_f32 v46, v46, s42, v38
  v_fma_f32 v47, v47, s42, v38
  v_fma_f32 v48, v48, s42, v38
  v_fma_f32 v49, v49, s42, v38
  v_fma_f32 v50, v50, s42, v38
  v_fma_f32 v51, v51, s42, v38
  v_fma_f32 v52, v52, s42, v38
  v_fma_f32 v53, v53, s42, v38
  v_fma_f32 v54, v54, s42, v38
  v_fma_f32 v55, v55, s42, v38
  v_mul_f32 v40, v40, v64
  v_mul_f32 v41, v41, v65
  v_mul_f32 v42, v42, v66
  v_mul_f32 v43, v43, v67
  v_mul_f32 v44, v44, v68
  v_mul_f32 v45, v45, v69
  v_mul_f32 v46, v46, v70
  v_mul_f32 v47, v47, v71
  v_mul_f32 v48, v48, v72
  v_mul_f32 v49, v49, v73
  v_mul_f32 v50, v50, v74
  v_mul_f32 v51, v51, v75
  v_mul_f32 v52, v52, v76
  v_mul_f32 v53, v53, v77
  v_mul_f32 v54, v54, v78
  v_mul_f32 v55, v55, v79
  v_cvt_pk_bf16_f32 v56, v40, v41
  v_cvt_pk_bf16_f32 v57, v42, v43
  v_cvt_pk_bf16_f32 v58, v44, v45
  v_cvt_pk_bf16_f32 v59, v46, v47
  buffer_store_dwordx4 v[56:59], v37, s[16:19], s41 offen offset:0 sc1
  v_cvt_pk_bf16_f32 v60, v48, v49
  v_cvt_pk_bf16_f32 v61, v50, v51
  v_cvt_pk_bf16_f32 v62, v52, v53
  v_cvt_pk_bf16_f32 v63, v54, v55
  buffer_store_dwordx4 v[60:63], v37, s[16:19], s41 offen offset:512 sc1
  ds_read_b128 v[112:115], v36 offset:20608
  ds_read_b128 v[116:119], v36 offset:20640
  ds_read_b128 v[120:123], v36 offset:20672
  ds_read_b128 v[124:127], v36 offset:20704
  v_fmac_f32 v88, v16, v110
  v_fmac_f32 v89, v17, v110
  v_fmac_f32 v90, v18, v110
  v_fmac_f32 v91, v19, v110
  v_fmac_f32 v92, v20, v110
  v_fmac_f32 v93, v21, v110
  v_fmac_f32 v94, v22, v110
  v_fmac_f32 v95, v23, v110
  v_fmac_f32 v96, v24, v110
  v_fmac_f32 v97, v25, v110
  v_fmac_f32 v98, v26, v110
  v_fmac_f32 v99, v27, v110
  v_fmac_f32 v100, v28, v110
  v_fmac_f32 v101, v29, v110
  v_fmac_f32 v102, v30, v110
  v_fmac_f32 v103, v31, v110
  s_waitcnt lgkmcnt(3)
  v_fmac_f32 v88, v112, v109
  v_fmac_f32 v89, v113, v109
  v_fmac_f32 v90, v114, v109
  v_fmac_f32 v91, v115, v109
  s_waitcnt lgkmcnt(2)
  v_fmac_f32 v92, v116, v109
  v_fmac_f32 v93, v117, v109
  v_fmac_f32 v94, v118, v109
  v_fmac_f32 v95, v119, v109
  s_waitcnt lgkmcnt(1)
  v_fmac_f32 v96, v120, v109
  v_fmac_f32 v97, v121, v109
  v_fmac_f32 v98, v122, v109
  v_fmac_f32 v99, v123, v109
  s_waitcnt lgkmcnt(0)
  v_fmac_f32 v100, v124, v109
  v_fmac_f32 v101, v125, v109
  v_fmac_f32 v102, v126, v109
  v_fmac_f32 v103, v127, v109
  v_exp_f32 v40, v88
  v_exp_f32 v41, v89
  v_exp_f32 v42, v90
  v_exp_f32 v43, v91
  v_exp_f32 v44, v92
  v_exp_f32 v45, v93
  v_exp_f32 v46, v94
  v_exp_f32 v47, v95
  v_exp_f32 v48, v96
  v_exp_f32 v49, v97
  v_exp_f32 v50, v98
  v_exp_f32 v51, v99
  v_exp_f32 v52, v100
  v_exp_f32 v53, v101
  v_exp_f32 v54, v102
  v_exp_f32 v55, v103
  v_add_f32 v40, 1.0, v40
  v_add_f32 v41, 1.0, v41
  v_add_f32 v42, 1.0, v42
  v_add_f32 v43, 1.0, v43
  v_add_f32 v44, 1.0, v44
  v_add_f32 v45, 1.0, v45
  v_add_f32 v46, 1.0, v46
  v_add_f32 v47, 1.0, v47
  v_add_f32 v48, 1.0, v48
  v_add_f32 v49, 1.0, v49
  v_add_f32 v50, 1.0, v50
  v_add_f32 v51, 1.0, v51
  v_add_f32 v52, 1.0, v52
  v_add_f32 v53, 1.0, v53
  v_add_f32 v54, 1.0, v54
  v_add_f32 v55, 1.0, v55
  v_fma_f32 v40, v40, v40, 1.0
  v_fma_f32 v41, v41, v41, 1.0
  v_fma_f32 v42, v42, v42, 1.0
  v_fma_f32 v43, v43, v43, 1.0
  v_fma_f32 v44, v44, v44, 1.0
  v_fma_f32 v45, v45, v45, 1.0
  v_fma_f32 v46, v46, v46, 1.0
  v_fma_f32 v47, v47, v47, 1.0
  v_fma_f32 v48, v48, v48, 1.0
  v_fma_f32 v49, v49, v49, 1.0
  v_fma_f32 v50, v50, v50, 1.0
  v_fma_f32 v51, v51, v51, 1.0
  v_fma_f32 v52, v52, v52, 1.0
  v_fma_f32 v53, v53, v53, 1.0
  v_fma_f32 v54, v54, v54, 1.0
  v_fma_f32 v55, v55, v55, 1.0
  v_rcp_f32 v40, v40
  v_rcp_f32 v41, v41
  v_rcp_f32 v42, v42
  v_rcp_f32 v43, v43
  v_rcp_f32 v44, v44
  v_rcp_f32 v45, v45
  v_rcp_f32 v46, v46
  v_rcp_f32 v47, v47
  v_rcp_f32 v48, v48
  v_rcp_f32 v49, v49
  v_rcp_f32 v50, v50
  v_rcp_f32 v51, v51
  v_rcp_f32 v52, v52
  v_rcp_f32 v53, v53
  v_rcp_f32 v54, v54
  v_rcp_f32 v55, v55
  v_fma_f32 v40, v40, s42, v38
  v_fma_f32 v41, v41, s42, v38
  v_fma_f32 v42, v42, s42, v38
  v_fma_f32 v43, v43, s42, v38
  v_fma_f32 v44, v44, s42, v38
  v_fma_f32 v45, v45, s42, v38
  v_fma_f32 v46, v46, s42, v38
  v_fma_f32 v47, v47, s42, v38
  v_fma_f32 v48, v48, s42, v38
  v_fma_f32 v49, v49, s42, v38
  v_fma_f32 v50, v50, s42, v38
  v_fma_f32 v51, v51, s42, v38
  v_fma_f32 v52, v52, s42, v38
  v_fma_f32 v53, v53, s42, v38
  v_fma_f32 v54, v54, s42, v38
  v_fma_f32 v55, v55, s42, v38
  v_mul_f32 v40, v40, v88
  v_mul_f32 v41, v41, v89
  v_mul_f32 v42, v42, v90
  v_mul_f32 v43, v43, v91
  v_mul_f32 v44, v44, v92
  v_mul_f32 v45, v45, v93
  v_mul_f32 v46, v46, v94
  v_mul_f32 v47, v47, v95
  v_mul_f32 v48, v48, v96
  v_mul_f32 v49, v49, v97
  v_mul_f32 v50, v50, v98
  v_mul_f32 v51, v51, v99
  v_mul_f32 v52, v52, v100
  v_mul_f32 v53, v53, v101
  v_mul_f32 v54, v54, v102
  v_mul_f32 v55, v55, v103
  v_cvt_pk_bf16_f32 v56, v40, v41
  v_cvt_pk_bf16_f32 v57, v42, v43
  v_cvt_pk_bf16_f32 v58, v44, v45
  v_cvt_pk_bf16_f32 v59, v46, v47
  buffer_store_dwordx4 v[56:59], v37, s[16:19], s41 offen offset:1024 sc1
  v_cvt_pk_bf16_f32 v60, v48, v49
  v_cvt_pk_bf16_f32 v61, v50, v51
  v_cvt_pk_bf16_f32 v62, v52, v53
  v_cvt_pk_bf16_f32 v63, v54, v55
  buffer_store_dwordx4 v[60:63], v37, s[16:19], s41 offen offset:1536 sc1
g1_done:
  s_nop 0
  s_endpgm
g1_spin:
  s_mov_b32 s61, 0
g1_spin_l:
  s_sleep 8
  s_mov_b64 exec, 1
  buffer_load_dword v68, v69, s[52:55], s50 offen sc1
  s_mov_b64 exec, -1
  s_waitcnt vmcnt(0)
  v_readfirstlane_b32 s60, v68
  s_add_u32 s61, s61, 1
  s_cmp_eq_u32 s60, 1
  s_cbranch_scc1 g1_spun
  s_cmp_lt_u32 s61, 0x200000
  s_cbranch_scc1 g1_spin_l
  s_branch g1_spun
.globl k2_kernel
.p2align 8
.type k2_kernel,@function
k2_kernel:
  s_cmp_lt_u32 s2, 256
  s_cbranch_scc1 L_g2
  s_sub_u32 s2, s2, 256
  s_cmp_lt_u32 s2, 256
  s_cbranch_scc1 L_conv
  s_endpgm
L_conv:
  s_setprio 3
  s_load_dwordx2 s[4:5], s[0:1], 120
  s_load_dwordx2 s[6:7], s[0:1], 64
  v_and_b32 v1, 63, v0
  v_lshrrev_b32 v2, 6, v0
  v_lshlrev_b32 v254, 4, v0
  v_lshrrev_b32 v4, 2, v0
  v_and_b32 v5, 3, v0
  v_mul_u32_u24 v255, 40960, v4
  v_lshl_add_u32 v255, v5, 4, v255
  v_mov_b32 v244, 0
  v_mov_b32 v245, 0
  v_mov_b32 v246, 0
  v_mov_b32 v247, 0
  s_add_u32 s40, s2, 256
  s_add_u32 s41, s2, 512
  s_min_u32 s42, s41, 639
  s_waitcnt lgkmcnt(0)
  s_add_u32 s8, s4, 13631488
  s_addc_u32 s9, s5, 0
  s_mov_b32 s10, 2662400
  s_mov_b32 s11, 0x00020000
  s_add_u32 s12, s4, 10485760
  s_addc_u32 s13, s5, 0
  s_mov_b32 s14, 2621440
  s_mov_b32 s15, 0x00020000
  s_add_u32 s16, s4, 16777216
  s_addc_u32 s17, s5, 0
  s_mov_b32 s18, 2560
  s_mov_b32 s19, 0x00020000
  s_mov_b32 s20, s6
  s_mov_b32 s21, s7
  s_mov_b32 s22, 1280
  s_mov_b32 s23, 0x00020000
  s_mul_i32 s3, s2, 4160
  s_lshl_b32 s28, s2, 6
  s_lshl_b32 s29, s2, 2
  s_lshl_b32 s30, s2, 1
  buffer_load_dwordx4 v[220:223], v254, s[8:11], s3 offen
  buffer_load_dwordx4 v[224:227], v254, s[8:11], s3 offen offset:16
  buffer_load_dwordx4 v[228:231], v255, s[12:15], s28 offen
  buffer_load_dword v248, v244, s[16:19], s29 offen
  buffer_load_ushort v249, v244, s[20:23], s30 offen
  s_add_u32 s24, s4, 17825792
  s_addc_u32 s25, s5, 0
  s_mov_b32 s26, 2621440
  s_mov_b32 s27, 0x00020000
  s_mov_b32 s43, 0xfffefffe
  v_lshlrev_b32 v8, 4, v5
  ds_write_b128 v8, v[244:247] offset:34816
  v_add_u32 v9, 40960, v8
  ds_write_b128 v9, v[244:247] offset:34816
  v_min_u32 v9, 2, v5
  v_and_b32 v10, 7, v4
  v_mul_u32_u24 v10, 4160, v10
  v_lshl_add_u32 v190, v9, 4, v10
  v_mul_u32_u24 v188, 80, v4
  v_add_u32 v188, v188, v8
  v_sub_u32 v189, 258, v0
  v_lshlrev_b32 v189, 4, v189
  v_and_b32 v3, 31, v1
  v_lshrrev_b32 v4, 5, v1
  v_and_b32 v5, 7, v3
  v_mul_u32_u24 v191, 4160, v5
  v_lshrrev_b32 v5, 3, v3
  v_sub_u32 v5, v5, v4
  v_add_u32 v5, 1, v5
  v_lshl_add_u32 v191, v5, 4, v191
  v_lshl_add_u32 v191, v2, 9, v191
  v_lshlrev_b32 v5, 3, v2
  v_sub_u32 v5, v3, v5
  v_mul_i32_i24 v5, 80, v5
  v_lshl_add_u32 v5, v4, 4, v5
  v_add_u32 v192, 36896, v5
  v_lshlrev_b32 v6, 4, v4
  v_add_u32 v6, 34816, v6
  v_add_u32 v196, 34896, v5
  v_max_i32 v196, v196, v6
  v_add_u32 v197, 34816, v5
  v_max_i32 v197, v197, v6
  v_add_u32 v198, 34736, v5
  v_max_i32 v198, v198, v6
  v_add_u32 v199, 34656, v5
  v_max_i32 v199, v199, v6
  v_add_u32 v200, 34576, v5
  v_max_i32 v200, v200, v6
  v_add_u32 v201, 34496, v5
  v_max_i32 v201, v201, v6
  v_add_u32 v202, 34416, v5
  v_max_i32 v202, v202, v6
  v_add_u32 v203, 34336, v5
  v_max_i32 v203, v203, v6
  v_mul_u32_u24 v193, 8704, v2
  v_lshl_add_u32 v193, v1, 4, v193
  v_lshrrev_b32 v4, 1, v2
  v_and_b32 v5, 3, v1
  v_lshl_add_u32 v4, v4, 2, v5
  v_mul_u32_u24 v194, 1088, v4
  v_and_b32 v6, 1, v2
  v_lshrrev_b32 v7, 2, v1
  v_lshl_add_u32 v6, v6, 4, v7
  v_lshl_add_u32 v194, v6, 4, v194
  v_lshl_add_u32 v6, v2, 4, v7
  v_mul_u32_u24 v195, 80, v6
  v_lshl_add_u32 v195, v5, 4, v195
  v_add_u32 v204, 40960, v188
  v_add_u32 v205, 40960, v189
  v_add_u32 v206, 40960, v190
  v_add_u32 v207, 40960, v191
  v_add_u32 v208, 40960, v192
  v_add_u32 v209, 40960, v193
  v_add_u32 v210, 40960, v194
  v_add_u32 v211, 40960, v195
  v_add_u32 v212, 40960, v196
  v_add_u32 v213, 40960, v197
  v_add_u32 v214, 40960, v198
  v_add_u32 v215, 40960, v199
  v_add_u32 v216, 40960, v200
  v_add_u32 v217, 40960, v201
  v_add_u32 v218, 40960, v202
  v_add_u32 v219, 40960, v203
  v_readfirstlane_b32 s38, v2
  s_waitcnt vmcnt(0)
  s_mul_i32 s3, s40, 4160
  s_lshl_b32 s28, s40, 6
  s_lshl_b32 s29, s40, 2
  s_lshl_b32 s30, s40, 1
  buffer_load_dwordx4 v[232:235], v254, s[8:11], s3 offen
  buffer_load_dwordx4 v[236:239], v254, s[8:11], s3 offen offset:16
  buffer_load_dwordx4 v[240:243], v255, s[12:15], s28 offen
  buffer_load_dword v250, v244, s[16:19], s29 offen
  buffer_load_ushort v251, v244, s[20:23], s30 offen
  v_mov_b32 v164, v221
  v_mov_b32 v165, v222
  v_mov_b32 v166, v223
  v_mov_b32 v167, v224
  v_mov_b32 v168, v225
  v_mov_b32 v169, v226
  v_alignbyte_b32 v172, v221, v220, 2
  v_alignbyte_b32 v173, v222, v221, 2
  v_alignbyte_b32 v174, v223, v222, 2
  v_alignbyte_b32 v175, v224, v223, 2
  v_alignbyte_b32 v176, v225, v224, 2
  v_alignbyte_b32 v177, v226, v225, 2
  v_alignbyte_b32 v178, v227, v226, 2
  v_alignbyte_b32 v180, v222, v221, 2
  v_alignbyte_b32 v181, v223, v222, 2
  v_alignbyte_b32 v182, v224, v223, 2
  v_alignbyte_b32 v183, v225, v224, 2
  v_alignbyte_b32 v184, v226, v225, 2
  v_alignbyte_b32 v185, v227, v226, 2
  v_lshlrev_b32 v249, 16, v249
  ds_write_b128 v188, v[228:231] offset:34896
  ds_write_b128 v190, v[244:247]
  ds_write_b128 v189, v[182:185] offset:0
  ds_write_b128 v189, v[166:169] offset:4160
  ds_write_b128 v189, v[174:177] offset:8320
  ds_write_b128 v189, v[222:225] offset:12480
  ds_write_b128 v189, v[180:183] offset:16640
  ds_write_b128 v189, v[164:167] offset:20800
  ds_write_b128 v189, v[172:175] offset:24960
  ds_write_b128 v189, v[220:223] offset:29120
  s_waitcnt lgkmcnt(0)
  s_barrier
  s_mul_i32 s3, s42, 4160
  s_lshl_b32 s28, s42, 6
  s_lshl_b32 s29, s42, 2
  s_lshl_b32 s30, s42, 1
  buffer_load_dwordx4 v[220:223], v254, s[8:11], s3 offen
  buffer_load_dwordx4 v[224:227], v254, s[8:11], s3 offen offset:16
  buffer_load_dwordx4 v[228:231], v255, s[12:15], s28 offen
  buffer_load_dword v252, v244, s[16:19], s29 offen
  buffer_load_ushort v253, v244, s[20:23], s30 offen
  s_setprio 3
  ds_read_b128 v[64:67], v191 offset:32
  ds_read_b128 v[72:75], v192 offset:560
  ds_read_b128 v[68:71], v196 offset:0
  ds_read_b128 v[76:79], v191 offset:2080
  ds_read_b128 v[80:83], v191 offset:0
  ds_read_b128 v[88:91], v192 offset:592
  ds_read_b128 v[84:87], v196 offset:32
  ds_read_b128 v[92:95], v191 offset:2048
  s_waitcnt lgkmcnt(4)
  v_mfma_f32_32x32x16_f16 v[16:31], v[64:67], v[72:75], 0
  ds_read_b128 v[96:99], v191 offset:96
  ds_read_b128 v[104:107], v192 offset:480
  v_mfma_f32_32x32x16_f16 v[0:15], v[64:67], v[68:71], 0
  ds_read_b128 v[100:103], v197 offset:0
  v_mfma_f32_32x32x16_f16 v[16:31], v[76:79], v[68:71], v[16:31]
  ds_read_b128 v[108:111], v191 offset:2144
  s_waitcnt vmcnt(5)
  v_mov_b32 v164, v233
  v_mov_b32 v165, v234
  s_waitcnt lgkmcnt(4)
  v_mfma_f32_32x32x16_f16 v[16:31], v[80:83], v[88:91], v[16:31]
  ds_read_b128 v[64:67], v191 offset:64
  ds_read_b128 v[72:75], v192 offset:512
  v_mov_b32 v166, v235
  v_mov_b32 v167, v236
  v_mov_b32 v168, v237
  v_mfma_f32_32x32x16_f16 v[0:15], v[80:83], v[84:87], v[0:15]
  ds_read_b128 v[68:71], v197 offset:32
  v_mov_b32 v169, v238
  v_alignbyte_b32 v172, v233, v232, 2
  v_alignbyte_b32 v173, v234, v233, 2
  v_mfma_f32_32x32x16_f16 v[16:31], v[92:95], v[84:87], v[16:31]
  ds_read_b128 v[76:79], v191 offset:2112
  v_alignbyte_b32 v174, v235, v234, 2
  v_alignbyte_b32 v175, v236, v235, 2
  v_alignbyte_b32 v176, v237, v236, 2
  s_waitcnt lgkmcnt(4)
  v_mfma_f32_32x32x16_f16 v[16:31], v[96:99], v[104:107], v[16:31]
  ds_read_b128 v[80:83], v191 offset:160
  ds_read_b128 v[88:91], v192 offset:400
  v_alignbyte_b32 v177, v238, v237, 2
  v_alignbyte_b32 v178, v239, v238, 2
  v_alignbyte_b32 v180, v234, v233, 2
  v_mfma_f32_32x32x16_f16 v[0:15], v[96:99], v[100:103], v[0:15]
  ds_read_b128 v[84:87], v198 offset:0
  v_alignbyte_b32 v181, v235, v234, 2
  v_alignbyte_b32 v182, v236, v235, 2
  v_alignbyte_b32 v183, v237, v236, 2
  v_mfma_f32_32x32x16_f16 v[16:31], v[108:111], v[100:103], v[16:31]
  ds_read_b128 v[92:95], v191 offset:2208
  v_alignbyte_b32 v184, v238, v237, 2
  v_alignbyte_b32 v185, v239, v238, 2
  v_lshlrev_b32 v251, 16, v251
  s_waitcnt lgkmcnt(4)
  v_mfma_f32_32x32x16_f16 v[16:31], v[64:67], v[72:75], v[16:31]
  ds_read_b128 v[96:99], v191 offset:128
  ds_read_b128 v[104:107], v192 offset:432
  v_mfma_f32_32x32x16_f16 v[0:15], v[64:67], v[68:71], v[0:15]
  ds_read_b128 v[100:103], v198 offset:32
  ds_write_b128 v204, v[240:243] offset:34896
  v_mfma_f32_32x32x16_f16 v[16:31], v[76:79], v[68:71], v[16:31]
  ds_read_b128 v[108:111], v191 offset:2176
  ds_write_b128 v206, v[244:247]
  s_waitcnt lgkmcnt(6)
  v_mfma_f32_32x32x16_f16 v[16:31], v[80:83], v[88:91], v[16:31]
  ds_read_b128 v[64:67], v191 offset:224
  ds_read_b128 v[72:75], v192 offset:320
  ds_write_b128 v205, v[182:185] offset:0
  v_mfma_f32_32x32x16_f16 v[0:15], v[80:83], v[84:87], v[0:15]
  ds_read_b128 v[68:71], v199 offset:0
  ds_write_b128 v205, v[166:169] offset:4160
  v_mfma_f32_32x32x16_f16 v[16:31], v[92:95], v[84:87], v[16:31]
  ds_read_b128 v[76:79], v191 offset:2272
  ds_write_b128 v205, v[174:177] offset:8320
  s_waitcnt lgkmcnt(8)
  v_mfma_f32_32x32x16_f16 v[16:31], v[96:99], v[104:107], v[16:31]
  ds_read_b128 v[80:83], v191 offset:192
  ds_read_b128 v[88:91], v192 offset:352
  ds_write_b128 v205, v[234:237] offset:12480
  v_mfma_f32_32x32x16_f16 v[0:15], v[96:99], v[100:103], v[0:15]
  ds_read_b128 v[84:87], v199 offset:32
  ds_write_b128 v205, v[180:183] offset:16640
  v_mfma_f32_32x32x16_f16 v[16:31], v[108:111], v[100:103], v[16:31]
  ds_read_b128 v[92:95], v191 offset:2240
  ds_write_b128 v205, v[164:167] offset:20800
  s_waitcnt lgkmcnt(8)
  v_mfma_f32_32x32x16_f16 v[16:31], v[64:67], v[72:75], v[16:31]
  ds_read_b128 v[96:99], v191 offset:288
  ds_read_b128 v[104:107], v192 offset:240
  ds_write_b128 v205, v[172:175] offset:24960
  v_mfma_f32_32x32x16_f16 v[0:15], v[64:67], v[68:71], v[0:15]
  ds_read_b128 v[100:103], v200 offset:0
  ds_write_b128 v205, v[232:235] offset:29120
  v_mfma_f32_32x32x16_f16 v[16:31], v[76:79], v[68:71], v[16:31]
  ds_read_b128 v[108:111], v191 offset:2336
  s_waitcnt lgkmcnt(7)
  v_mfma_f32_32x32x16_f16 v[16:31], v[80:83], v[88:91], v[16:31]
  ds_read_b128 v[64:67], v191 offset:256
  ds_read_b128 v[72:75], v192 offset:272
  v_mfma_f32_32x32x16_f16 v[0:15], v[80:83], v[84:87], v[0:15]
  ds_read_b128 v[68:71], v200 offset:32
  v_mfma_f32_32x32x16_f16 v[16:31], v[92:95], v[84:87], v[16:31]
  ds_read_b128 v[76:79], v191 offset:2304
  s_waitcnt lgkmcnt(4)
  v_mfma_f32_32x32x16_f16 v[16:31], v[96:99], v[104:107], v[16:31]
  ds_read_b128 v[80:83], v191 offset:352
  ds_read_b128 v[88:91], v192 offset:160
  v_mfma_f32_32x32x16_f16 v[0:15], v[96:99], v[100:103], v[0:15]
  ds_read_b128 v[84:87], v201 offset:0
  v_mfma_f32_32x32x16_f16 v[16:31], v[108:111], v[100:103], v[16:31]
  ds_read_b128 v[92:95], v191 offset:2400
  s_waitcnt lgkmcnt(4)
  v_mfma_f32_32x32x16_f16 v[16:31], v[64:67], v[72:75], v[16:31]
  ds_read_b128 v[96:99], v191 offset:320
  ds_read_b128 v[104:107], v192 offset:192
  v_mfma_f32_32x32x16_f16 v[0:15], v[64:67], v[68:71], v[0:15]
  ds_read_b128 v[100:103], v201 offset:32
  v_mfma_f32_32x32x16_f16 v[16:31], v[76:79], v[68:71], v[16:31]
  ds_read_b128 v[108:111], v191 offset:2368
  s_waitcnt lgkmcnt(4)
  v_mfma_f32_32x32x16_f16 v[16:31], v[80:83], v[88:91], v[16:31]
  ds_read_b128 v[64:67], v191 offset:416
  ds_read_b128 v[72:75], v192 offset:80
  v_mfma_f32_32x32x16_f16 v[0:15], v[80:83], v[84:87], v[0:15]
  ds_read_b128 v[68:71], v202 offset:0
  v_mfma_f32_32x32x16_f16 v[16:31], v[92:95], v[84:87], v[16:31]
  ds_read_b128 v[76:79], v191 offset:2464
  s_waitcnt lgkmcnt(4)
  v_mfma_f32_32x32x16_f16 v[16:31], v[96:99], v[104:107], v[16:31]
  ds_read_b128 v[80:83], v191 offset:384
  ds_read_b128 v[88:91], v192 offset:112
  v_mfma_f32_32x32x16_f16 v[0:15], v[96:99], v[100:103], v[0:15]
  ds_read_b128 v[84:87], v202 offset:32
  v_mfma_f32_32x32x16_f16 v[16:31], v[108:111], v[100:103], v[16:31]
  ds_read_b128 v[92:95], v191 offset:2432
  s_waitcnt lgkmcnt(4)
  v_mfma_f32_32x32x16_f16 v[16:31], v[64:67], v[72:75], v[16:31]
  ds_read_b128 v[96:99], v191 offset:480
  ds_read_b128 v[104:107], v192 offset:0
  v_mfma_f32_32x32x16_f16 v[0:15], v[64:67], v[68:71], v[0:15]
  ds_read_b128 v[100:103], v203 offset:0
  v_mfma_f32_32x32x16_f16 v[16:31], v[76:79], v[68:71], v[16:31]
  ds_read_b128 v[108:111], v191 offset:2528
  s_waitcnt lgkmcnt(4)
  v_mfma_f32_32x32x16_f16 v[16:31], v[80:83], v[88:91], v[16:31]
  ds_read_b128 v[64:67], v191 offset:448
  ds_read_b128 v[72:75], v192 offset:32
  v_mfma_f32_32x32x16_f16 v[0:15], v[80:83], v[84:87], v[0:15]
  ds_read_b128 v[68:71], v203 offset:32
  v_mfma_f32_32x32x16_f16 v[16:31], v[92:95], v[84:87], v[16:31]
  ds_read_b128 v[76:79], v191 offset:2496
  s_waitcnt lgkmcnt(4)
  v_mfma_f32_32x32x16_f16 v[16:31], v[96:99], v[104:107], v[16:31]
  v_mfma_f32_32x32x16_f16 v[0:15], v[96:99], v[100:103], v[0:15]
  v_mfma_f32_32x32x16_f16 v[16:31], v[108:111], v[100:103], v[16:31]
  s_waitcnt lgkmcnt(0)
  v_mfma_f32_32x32x16_f16 v[16:31], v[64:67], v[72:75], v[16:31]
  v_mfma_f32_32x32x16_f16 v[0:15], v[64:67], v[68:71], v[0:15]
  v_mfma_f32_32x32x16_f16 v[16:31], v[76:79], v[68:71], v[16:31]
  s_waitcnt lgkmcnt(0)
  s_barrier
  s_cmp_lt_u32 s41, 640
  s_cbranch_scc0 conv_two
  ds_read_b128 v[64:67], v207 offset:32
  ds_read_b128 v[72:75], v208 offset:560
  ds_read_b128 v[68:71], v212 offset:0
  ds_read_b128 v[76:79], v207 offset:2080
  ds_read_b128 v[80:83], v207 offset:0
  ds_read_b128 v[88:91], v208 offset:592
  ds_read_b128 v[84:87], v212 offset:32
  ds_read_b128 v[92:95], v207 offset:2048
  s_waitcnt lgkmcnt(4)
  v_mfma_f32_32x32x16_f16 v[48:63], v[64:67], v[72:75], 0
  ds_read_b128 v[96:99], v207 offset:96
  ds_read_b128 v[104:107], v208 offset:480
  v_mfma_f32_32x32x16_f16 v[32:47], v[64:67], v[68:71], 0
  ds_read_b128 v[100:103], v213 offset:0
  ds_read_b128 v[144:147], v195 offset:34896
  v_mfma_f32_32x32x16_f16 v[48:63], v[76:79], v[68:71], v[48:63]
  ds_read_b128 v[108:111], v207 offset:2144
  ds_write_b128 v193, v[0:3] offset:0
  s_waitcnt lgkmcnt(6)
  v_mfma_f32_32x32x16_f16 v[48:63], v[80:83], v[88:91], v[48:63]
  ds_read_b128 v[64:67], v207 offset:64
  ds_read_b128 v[72:75], v208 offset:512
  ds_write_b128 v193, v[4:7] offset:1088
  v_mfma_f32_32x32x16_f16 v[32:47], v[80:83], v[84:87], v[32:47]
  ds_read_b128 v[68:71], v213 offset:32
  ds_write_b128 v193, v[8:11] offset:2176
  v_mfma_f32_32x32x16_f16 v[48:63], v[92:95], v[84:87], v[48:63]
  ds_read_b128 v[76:79], v207 offset:2112
  ds_write_b128 v193, v[12:15] offset:3264
  s_waitcnt lgkmcnt(8)
  v_mfma_f32_32x32x16_f16 v[48:63], v[96:99], v[104:107], v[48:63]
  ds_read_b128 v[80:83], v207 offset:160
  ds_read_b128 v[88:91], v208 offset:400
  ds_write_b128 v193, v[16:19] offset:4352
  v_mfma_f32_32x32x16_f16 v[32:47], v[96:99], v[100:103], v[32:47]
  ds_read_b128 v[84:87], v214 offset:0
  ds_write_b128 v193, v[20:23] offset:5440
  v_mfma_f32_32x32x16_f16 v[48:63], v[108:111], v[100:103], v[48:63]
  ds_read_b128 v[92:95], v207 offset:2208
  ds_write_b128 v193, v[24:27] offset:6528
  s_waitcnt lgkmcnt(8)
  v_mfma_f32_32x32x16_f16 v[48:63], v[64:67], v[72:75], v[48:63]
  ds_read_b128 v[96:99], v207 offset:128
  ds_read_b128 v[104:107], v208 offset:432
  ds_write_b128 v193, v[28:31] offset:7616
  v_mfma_f32_32x32x16_f16 v[32:47], v[64:67], v[68:71], v[32:47]
  ds_read_b128 v[100:103], v214 offset:32
  v_mfma_f32_32x32x16_f16 v[48:63], v[76:79], v[68:71], v[48:63]
  ds_read_b128 v[108:111], v207 offset:2176
  s_waitcnt lgkmcnt(6)
  v_mfma_f32_32x32x16_f16 v[48:63], v[80:83], v[88:91], v[48:63]
  ds_read_b128 v[64:67], v207 offset:224
  ds_read_b128 v[72:75], v208 offset:320
  v_mfma_f32_32x32x16_f16 v[32:47], v[80:83], v[84:87], v[32:47]
  ds_read_b128 v[68:71], v215 offset:0
  s_waitcnt lgkmcnt(0)
  s_barrier
  v_mfma_f32_32x32x16_f16 v[48:63], v[92:95], v[84:87], v[48:63]
  ds_read_b128 v[76:79], v207 offset:2272
  ds_read_b128 v[112:115], v194 offset:0
  ds_read_b128 v[116:119], v194 offset:512
  ds_read_b128 v[120:123], v194 offset:8704
  ds_read_b128 v[124:127], v194 offset:9216
  ds_read_b128 v[128:131], v194 offset:17408
  v_mfma_f32_32x32x16_f16 v[48:63], v[96:99], v[104:107], v[48:63]
  ds_read_b128 v[80:83], v207 offset:192
  ds_read_b128 v[88:91], v208 offset:352
  ds_read_b128 v[132:135], v194 offset:17920
  ds_read_b128 v[136:139], v194 offset:26112
  ds_read_b128 v[140:143], v194 offset:26624
  v_fma_mix_f32 v148, v144, v249, 0 op_sel:[0,0,0] op_sel_hi:[1,0,0]
  v_fma_mix_f32 v149, v144, v249, 0 op_sel:[1,0,0] op_sel_hi:[1,0,0]
  v_mfma_f32_32x32x16_f16 v[32:47], v[96:99], v[100:103], v[32:47]
  ds_read_b128 v[84:87], v215 offset:32
  v_fma_mix_f32 v150, v145, v249, 0 op_sel:[0,0,0] op_sel_hi:[1,0,0]
  v_fma_mix_f32 v151, v145, v249, 0 op_sel:[1,0,0] op_sel_hi:[1,0,0]
  v_fma_mix_f32 v152, v146, v249, 0 op_sel:[0,0,0] op_sel_hi:[1,0,0]
  v_fma_mix_f32 v153, v146, v249, 0 op_sel:[1,0,0] op_sel_hi:[1,0,0]
  v_fma_mix_f32 v154, v147, v249, 0 op_sel:[0,0,0] op_sel_hi:[1,0,0]
  v_mfma_f32_32x32x16_f16 v[48:63], v[108:111], v[100:103], v[48:63]
  ds_read_b128 v[92:95], v207 offset:2240
  v_fma_mix_f32 v155, v147, v249, 0 op_sel:[1,0,0] op_sel_hi:[1,0,0]
  v_cvt_pk_bf16_f32 v156, v148, v149
  v_cvt_pk_bf16_f32 v157, v150, v151
  v_cvt_pk_bf16_f32 v158, v152, v153
  v_cvt_pk_bf16_f32 v159, v154, v155
  s_waitcnt lgkmcnt(12)
  v_mfma_f32_32x32x16_f16 v[48:63], v[64:67], v[72:75], v[48:63]
  ds_read_b128 v[96:99], v207 offset:288
  ds_read_b128 v[104:107], v208 offset:240
  v_lshlrev_b32 v148, 16, v156
  v_and_b32 v149, 0xffff0000, v156
  v_lshlrev_b32 v150, 16, v157
  v_and_b32 v151, 0xffff0000, v157
  v_lshlrev_b32 v152, 16, v158
  v_mfma_f32_32x32x16_f16 v[32:47], v[64:67], v[68:71], v[32:47]
  ds_read_b128 v[100:103], v216 offset:0
  v_and_b32 v153, 0xffff0000, v158
  v_lshlrev_b32 v154, 16, v159
  v_and_b32 v155, 0xffff0000, v159
  s_waitcnt lgkmcnt(5)
  v_mfma_f32_32x32x16_f16 v[48:63], v[76:79], v[68:71], v[48:63]
  ds_read_b128 v[108:111], v207 offset:2336
  s_waitcnt lgkmcnt(4)
  v_mfma_f32_32x32x16_f16 v[48:63], v[80:83], v[88:91], v[48:63]
  ds_read_b128 v[64:67], v207 offset:256
  ds_read_b128 v[72:75], v208 offset:272
  s_barrier
  v_add_f32 v112, v112, v120
  v_add_f32 v113, v113, v121
  v_add_f32 v114, v114, v122
  v_add_f32 v115, v115, v123
  v_add_f32 v116, v116, v124
  v_mfma_f32_32x32x16_f16 v[32:47], v[80:83], v[84:87], v[32:47]
  ds_read_b128 v[68:71], v216 offset:32
  s_waitcnt vmcnt(0)
  v_mov_b32 v164, v221
  v_mov_b32 v165, v222
  v_mov_b32 v166, v223
  v_mov_b32 v167, v224
  v_add_f32 v117, v117, v125
  v_add_f32 v118, v118, v126
  v_add_f32 v119, v119, v127
  v_add_f32 v128, v128, v136
  v_add_f32 v129, v129, v137
  v_mfma_f32_32x32x16_f16 v[48:63], v[92:95], v[84:87], v[48:63]
  ds_read_b128 v[76:79], v207 offset:2304
  v_mov_b32 v168, v225
  v_mov_b32 v169, v226
  v_alignbyte_b32 v172, v221, v220, 2
  v_alignbyte_b32 v173, v222, v221, 2
  v_alignbyte_b32 v174, v223, v222, 2
  v_add_f32 v130, v130, v138
  v_add_f32 v131, v131, v139
  v_add_f32 v132, v132, v140
  v_add_f32 v133, v133, v141
  v_add_f32 v134, v134, v142
  s_waitcnt lgkmcnt(4)
  v_mfma_f32_32x32x16_f16 v[48:63], v[96:99], v[104:107], v[48:63]
  ds_read_b128 v[80:83], v207 offset:352
  ds_read_b128 v[88:91], v208 offset:160
  v_alignbyte_b32 v175, v224, v223, 2
  v_alignbyte_b32 v176, v225, v224, 2
  v_alignbyte_b32 v177, v226, v225, 2
  v_alignbyte_b32 v178, v227, v226, 2
  v_alignbyte_b32 v180, v222, v221, 2
  v_add_f32 v135, v135, v143
  v_add_f32 v112, v112, v128
  v_add_f32 v113, v113, v129
  v_add_f32 v114, v114, v130
  v_add_f32 v115, v115, v131
  v_mfma_f32_32x32x16_f16 v[32:47], v[96:99], v[100:103], v[32:47]
  ds_read_b128 v[84:87], v217 offset:0
  v_alignbyte_b32 v181, v223, v222, 2
  v_alignbyte_b32 v182, v224, v223, 2
  v_alignbyte_b32 v183, v225, v224, 2
  v_alignbyte_b32 v184, v226, v225, 2
  v_alignbyte_b32 v185, v227, v226, 2
  v_add_f32 v116, v116, v132
  v_add_f32 v117, v117, v133
  v_add_f32 v118, v118, v134
  v_add_f32 v119, v119, v135
  v_mul_f32 v112, v112, v248
  v_mfma_f32_32x32x16_f16 v[48:63], v[108:111], v[100:103], v[48:63]
  ds_read_b128 v[92:95], v207 offset:2400
  v_lshlrev_b32 v253, 16, v253
  v_mul_f32 v113, v113, v248
  v_mul_f32 v114, v114, v248
  v_mul_f32 v115, v115, v248
  v_mul_f32 v116, v116, v248
  v_mul_f32 v117, v117, v248
  s_waitcnt lgkmcnt(4)
  v_mfma_f32_32x32x16_f16 v[48:63], v[64:67], v[72:75], v[48:63]
  ds_read_b128 v[96:99], v207 offset:320
  ds_read_b128 v[104:107], v208 offset:192
  ds_write_b128 v188, v[228:231] offset:34896
  v_mul_f32 v118, v118, v248
  v_mul_f32 v119, v119, v248
  v_cvt_pk_bf16_f32 v156, v112, v113
  v_cvt_pk_bf16_f32 v157, v114, v115
  v_cvt_pk_bf16_f32 v158, v116, v117
  v_mfma_f32_32x32x16_f16 v[32:47], v[64:67], v[68:71], v[32:47]
  ds_read_b128 v[100:103], v217 offset:32
  ds_write_b128 v190, v[244:247]
  v_cvt_pk_bf16_f32 v159, v118, v119
  v_lshlrev_b32 v112, 16, v156
  v_and_b32 v113, 0xffff0000, v156
  v_lshlrev_b32 v114, 16, v157
  v_and_b32 v115, 0xffff0000, v157
  v_mfma_f32_32x32x16_f16 v[48:63], v[76:79], v[68:71], v[48:63]
  ds_read_b128 v[108:111], v207 offset:2368
  ds_write_b128 v189, v[182:185] offset:0
  v_lshlrev_b32 v116, 16, v158
  v_and_b32 v117, 0xffff0000, v158
  v_lshlrev_b32 v118, 16, v159
  v_and_b32 v119, 0xffff0000, v159
  v_add_f32 v112, v112, v148
  s_waitcnt lgkmcnt(7)
  v_mfma_f32_32x32x16_f16 v[48:63], v[80:83], v[88:91], v[48:63]
  ds_read_b128 v[64:67], v207 offset:416
  ds_read_b128 v[72:75], v208 offset:80
  ds_write_b128 v189, v[166:169] offset:4160
  v_add_f32 v113, v113, v149
  v_add_f32 v114, v114, v150
  v_add_f32 v115, v115, v151
  v_add_f32 v116, v116, v152
  v_add_f32 v117, v117, v153
  v_mfma_f32_32x32x16_f16 v[32:47], v[80:83], v[84:87], v[32:47]
  ds_read_b128 v[68:71], v218 offset:0
  ds_write_b128 v189, v[174:177] offset:8320
  v_add_f32 v118, v118, v154
  v_add_f32 v119, v119, v155
  v_cvt_pk_bf16_f32 v160, v112, v113
  v_cvt_pk_bf16_f32 v161, v114, v115
  v_cvt_pk_bf16_f32 v162, v116, v117
  v_mfma_f32_32x32x16_f16 v[48:63], v[92:95], v[84:87], v[48:63]
  ds_read_b128 v[76:79], v207 offset:2464
  ds_write_b128 v189, v[222:225] offset:12480
  v_cvt_pk_bf16_f32 v163, v118, v119
  v_pk_min_u16 v160, v160, s43
  v_pk_min_u16 v161, v161, s43
  v_pk_min_u16 v162, v162, s43
  v_pk_min_u16 v163, v163, s43
  s_waitcnt lgkmcnt(8)
  v_mfma_f32_32x32x16_f16 v[48:63], v[96:99], v[104:107], v[48:63]
  ds_read_b128 v[80:83], v207 offset:384
  ds_read_b128 v[88:91], v208 offset:112
  ds_write_b128 v189, v[180:183] offset:16640
  s_lshl_b32 s31, s2, 12
  s_setprio 3
  buffer_store_dwordx4 v[160:163], v254, s[24:27], s31 offen sc1
  s_setprio 3
  v_mfma_f32_32x32x16_f16 v[32:47], v[96:99], v[100:103], v[32:47]
  ds_read_b128 v[84:87], v218 offset:32
  ds_write_b128 v189, v[164:167] offset:20800
  v_mfma_f32_32x32x16_f16 v[48:63], v[108:111], v[100:103], v[48:63]
  ds_read_b128 v[92:95], v207 offset:2432
  ds_write_b128 v189, v[172:175] offset:24960
  s_waitcnt lgkmcnt(8)
  v_mfma_f32_32x32x16_f16 v[48:63], v[64:67], v[72:75], v[48:63]
  ds_read_b128 v[96:99], v207 offset:480
  ds_read_b128 v[104:107], v208 offset:0
  ds_write_b128 v189, v[220:223] offset:29120
  v_mfma_f32_32x32x16_f16 v[32:47], v[64:67], v[68:71], v[32:47]
  ds_read_b128 v[100:103], v219 offset:0
  v_mfma_f32_32x32x16_f16 v[48:63], v[76:79], v[68:71], v[48:63]
  ds_read_b128 v[108:111], v207 offset:2528
  s_waitcnt lgkmcnt(6)
  v_mfma_f32_32x32x16_f16 v[48:63], v[80:83], v[88:91], v[48:63]
  ds_read_b128 v[64:67], v207 offset:448
  ds_read_b128 v[72:75], v208 offset:32
  v_mfma_f32_32x32x16_f16 v[32:47], v[80:83], v[84:87], v[32:47]
  ds_read_b128 v[68:71], v219 offset:32
  v_mfma_f32_32x32x16_f16 v[48:63], v[92:95], v[84:87], v[48:63]
  ds_read_b128 v[76:79], v207 offset:2496
  s_waitcnt lgkmcnt(4)
  v_mfma_f32_32x32x16_f16 v[48:63], v[96:99], v[104:107], v[48:63]
  v_mfma_f32_32x32x16_f16 v[32:47], v[96:99], v[100:103], v[32:47]
  v_mfma_f32_32x32x16_f16 v[48:63], v[108:111], v[100:103], v[48:63]
  s_waitcnt lgkmcnt(0)
  v_mfma_f32_32x32x16_f16 v[48:63], v[64:67], v[72:75], v[48:63]
  v_mfma_f32_32x32x16_f16 v[32:47], v[64:67], v[68:71], v[32:47]
  v_mfma_f32_32x32x16_f16 v[48:63], v[76:79], v[68:71], v[48:63]
  s_waitcnt lgkmcnt(0)
  s_barrier
  ds_read_b128 v[64:67], v191 offset:32
  ds_read_b128 v[72:75], v192 offset:560
  ds_read_b128 v[68:71], v196 offset:0
  ds_read_b128 v[76:79], v191 offset:2080
  ds_read_b128 v[80:83], v191 offset:0
  ds_read_b128 v[88:91], v192 offset:592
  ds_read_b128 v[84:87], v196 offset:32
  ds_read_b128 v[92:95], v191 offset:2048
  s_waitcnt lgkmcnt(4)
  v_mfma_f32_32x32x16_f16 v[16:31], v[64:67], v[72:75], 0
  ds_read_b128 v[96:99], v191 offset:96
  ds_read_b128 v[104:107], v192 offset:480
  v_mfma_f32_32x32x16_f16 v[0:15], v[64:67], v[68:71], 0
  ds_read_b128 v[100:103], v197 offset:0
  ds_read_b128 v[144:147], v211 offset:34896
  v_mfma_f32_32x32x16_f16 v[16:31], v[76:79], v[68:71], v[16:31]
  ds_read_b128 v[108:111], v191 offset:2144
  ds_write_b128 v209, v[32:35] offset:0
  s_waitcnt lgkmcnt(6)
  v_mfma_f32_32x32x16_f16 v[16:31], v[80:83], v[88:91], v[16:31]
  ds_read_b128 v[64:67], v191 offset:64
  ds_read_b128 v[72:75], v192 offset:512
  ds_write_b128 v209, v[36:39] offset:1088
  v_mfma_f32_32x32x16_f16 v[0:15], v[80:83], v[84:87], v[0:15]
  ds_read_b128 v[68:71], v197 offset:32
  ds_write_b128 v209, v[40:43] offset:2176
  v_mfma_f32_32x32x16_f16 v[16:31], v[92:95], v[84:87], v[16:31]
  ds_read_b128 v[76:79], v191 offset:2112
  ds_write_b128 v209, v[44:47] offset:3264
  s_waitcnt lgkmcnt(8)
  v_mfma_f32_32x32x16_f16 v[16:31], v[96:99], v[104:107], v[16:31]
  ds_read_b128 v[80:83], v191 offset:160
  ds_read_b128 v[88:91], v192 offset:400
  ds_write_b128 v209, v[48:51] offset:4352
  v_mfma_f32_32x32x16_f16 v[0:15], v[96:99], v[100:103], v[0:15]
  ds_read_b128 v[84:87], v198 offset:0
  ds_write_b128 v209, v[52:55] offset:5440
  v_mfma_f32_32x32x16_f16 v[16:31], v[108:111], v[100:103], v[16:31]
  ds_read_b128 v[92:95], v191 offset:2208
  ds_write_b128 v209, v[56:59] offset:6528
  s_waitcnt lgkmcnt(8)
  v_mfma_f32_32x32x16_f16 v[16:31], v[64:67], v[72:75], v[16:31]
  ds_read_b128 v[96:99], v191 offset:128
  ds_read_b128 v[104:107], v192 offset:432
  ds_write_b128 v209, v[60:63] offset:7616
  v_mfma_f32_32x32x16_f16 v[0:15], v[64:67], v[68:71], v[0:15]
  ds_read_b128 v[100:103], v198 offset:32
  v_mfma_f32_32x32x16_f16 v[16:31], v[76:79], v[68:71], v[16:31]
  ds_read_b128 v[108:111], v191 offset:2176
  s_waitcnt lgkmcnt(6)
  v_mfma_f32_32x32x16_f16 v[16:31], v[80:83], v[88:91], v[16:31]
  ds_read_b128 v[64:67], v191 offset:224
  ds_read_b128 v[72:75], v192 offset:320
  v_mfma_f32_32x32x16_f16 v[0:15], v[80:83], v[84:87], v[0:15]
  ds_read_b128 v[68:71], v199 offset:0
  s_waitcnt lgkmcnt(0)
  s_barrier
  v_mfma_f32_32x32x16_f16 v[16:31], v[92:95], v[84:87], v[16:31]
  ds_read_b128 v[76:79], v191 offset:2272
  ds_read_b128 v[112:115], v210 offset:0
  ds_read_b128 v[116:119], v210 offset:512
  ds_read_b128 v[120:123], v210 offset:8704
  ds_read_b128 v[124:127], v210 offset:9216
  ds_read_b128 v[128:131], v210 offset:17408
  v_mfma_f32_32x32x16_f16 v[16:31], v[96:99], v[104:107], v[16:31]
  ds_read_b128 v[80:83], v191 offset:192
  ds_read_b128 v[88:91], v192 offset:352
  ds_read_b128 v[132:135], v210 offset:17920
  ds_read_b128 v[136:139], v210 offset:26112
  ds_read_b128 v[140:143], v210 offset:26624
  v_fma_mix_f32 v148, v144, v251, 0 op_sel:[0,0,0] op_sel_hi:[1,0,0]
  v_fma_mix_f32 v149, v144, v251, 0 op_sel:[1,0,0] op_sel_hi:[1,0,0]
  v_mfma_f32_32x32x16_f16 v[0:15], v[96:99], v[100:103], v[0:15]
  ds_read_b128 v[84:87], v199 offset:32
  v_fma_mix_f32 v150, v145, v251, 0 op_sel:[0,0,0] op_sel_hi:[1,0,0]
  v_fma_mix_f32 v151, v145, v251, 0 op_sel:[1,0,0] op_sel_hi:[1,0,0]
  v_fma_mix_f32 v152, v146, v251, 0 op_sel:[0,0,0] op_sel_hi:[1,0,0]
  v_fma_mix_f32 v153, v146, v251, 0 op_sel:[1,0,0] op_sel_hi:[1,0,0]
  v_fma_mix_f32 v154, v147, v251, 0 op_sel:[0,0,0] op_sel_hi:[1,0,0]
  v_mfma_f32_32x32x16_f16 v[16:31], v[108:111], v[100:103], v[16:31]
  ds_read_b128 v[92:95], v191 offset:2240
  v_fma_mix_f32 v155, v147, v251, 0 op_sel:[1,0,0] op_sel_hi:[1,0,0]
  v_cvt_pk_bf16_f32 v156, v148, v149
  v_cvt_pk_bf16_f32 v157, v150, v151
  v_cvt_pk_bf16_f32 v158, v152, v153
  v_cvt_pk_bf16_f32 v159, v154, v155
  s_waitcnt lgkmcnt(12)
  v_mfma_f32_32x32x16_f16 v[16:31], v[64:67], v[72:75], v[16:31]
  ds_read_b128 v[96:99], v191 offset:288
  ds_read_b128 v[104:107], v192 offset:240
  v_lshlrev_b32 v148, 16, v156
  v_and_b32 v149, 0xffff0000, v156
  v_lshlrev_b32 v150, 16, v157
  v_and_b32 v151, 0xffff0000, v157
  v_lshlrev_b32 v152, 16, v158
  v_mfma_f32_32x32x16_f16 v[0:15], v[64:67], v[68:71], v[0:15]
  ds_read_b128 v[100:103], v200 offset:0
  v_and_b32 v153, 0xffff0000, v158
  v_lshlrev_b32 v154, 16, v159
  v_and_b32 v155, 0xffff0000, v159
  s_waitcnt lgkmcnt(5)
  v_mfma_f32_32x32x16_f16 v[16:31], v[76:79], v[68:71], v[16:31]
  ds_read_b128 v[108:111], v191 offset:2336
  s_waitcnt lgkmcnt(4)
  v_mfma_f32_32x32x16_f16 v[16:31], v[80:83], v[88:91], v[16:31]
  ds_read_b128 v[64:67], v191 offset:256
  ds_read_b128 v[72:75], v192 offset:272
  v_add_f32 v112, v112, v120
  v_add_f32 v113, v113, v121
  v_add_f32 v114, v114, v122
  v_add_f32 v115, v115, v123
  v_add_f32 v116, v116, v124
  v_mfma_f32_32x32x16_f16 v[0:15], v[80:83], v[84:87], v[0:15]
  ds_read_b128 v[68:71], v200 offset:32
  v_add_f32 v117, v117, v125
  v_add_f32 v118, v118, v126
  v_add_f32 v119, v119, v127
  v_add_f32 v128, v128, v136
  v_add_f32 v129, v129, v137
  v_mfma_f32_32x32x16_f16 v[16:31], v[92:95], v[84:87], v[16:31]
  ds_read_b128 v[76:79], v191 offset:2304
  v_add_f32 v130, v130, v138
  v_add_f32 v131, v131, v139
  v_add_f32 v132, v132, v140
  v_add_f32 v133, v133, v141
  v_add_f32 v134, v134, v142
  s_waitcnt lgkmcnt(4)
  v_mfma_f32_32x32x16_f16 v[16:31], v[96:99], v[104:107], v[16:31]
  ds_read_b128 v[80:83], v191 offset:352
  ds_read_b128 v[88:91], v192 offset:160
  v_add_f32 v135, v135, v143
  v_add_f32 v112, v112, v128
  v_add_f32 v113, v113, v129
  v_add_f32 v114, v114, v130
  v_add_f32 v115, v115, v131
  v_mfma_f32_32x32x16_f16 v[0:15], v[96:99], v[100:103], v[0:15]
  ds_read_b128 v[84:87], v201 offset:0
  v_add_f32 v116, v116, v132
  v_add_f32 v117, v117, v133
  v_add_f32 v118, v118, v134
  v_add_f32 v119, v119, v135
  v_mul_f32 v112, v112, v250
  v_mfma_f32_32x32x16_f16 v[16:31], v[108:111], v[100:103], v[16:31]
  ds_read_b128 v[92:95], v191 offset:2400
  v_mul_f32 v113, v113, v250
  v_mul_f32 v114, v114, v250
  v_mul_f32 v115, v115, v250
  v_mul_f32 v116, v116, v250
  v_mul_f32 v117, v117, v250
  s_waitcnt lgkmcnt(4)
  v_mfma_f32_32x32x16_f16 v[16:31], v[64:67], v[72:75], v[16:31]
  ds_read_b128 v[96:99], v191 offset:320
  ds_read_b128 v[104:107], v192 offset:192
  v_mul_f32 v118, v118, v250
  v_mul_f32 v119, v119, v250
  v_cvt_pk_bf16_f32 v156, v112, v113
  v_cvt_pk_bf16_f32 v157, v114, v115
  v_cvt_pk_bf16_f32 v158, v116, v117
  v_mfma_f32_32x32x16_f16 v[0:15], v[64:67], v[68:71], v[0:15]
  ds_read_b128 v[100:103], v201 offset:32
  v_cvt_pk_bf16_f32 v159, v118, v119
  v_lshlrev_b32 v112, 16, v156
  v_and_b32 v113, 0xffff0000, v156
  v_lshlrev_b32 v114, 16, v157
  v_and_b32 v115, 0xffff0000, v157
  v_mfma_f32_32x32x16_f16 v[16:31], v[76:79], v[68:71], v[16:31]
  ds_read_b128 v[108:111], v191 offset:2368
  v_lshlrev_b32 v116, 16, v158
  v_and_b32 v117, 0xffff0000, v158
  v_lshlrev_b32 v118, 16, v159
  v_and_b32 v119, 0xffff0000, v159
  v_add_f32 v112, v112, v148
  s_waitcnt lgkmcnt(4)
  v_mfma_f32_32x32x16_f16 v[16:31], v[80:83], v[88:91], v[16:31]
  ds_read_b128 v[64:67], v191 offset:416
  ds_read_b128 v[72:75], v192 offset:80
  v_add_f32 v113, v113, v149
  v_add_f32 v114, v114, v150
  v_add_f32 v115, v115, v151
  v_add_f32 v116, v116, v152
  v_add_f32 v117, v117, v153
  v_mfma_f32_32x32x16_f16 v[0:15], v[80:83], v[84:87], v[0:15]
  ds_read_b128 v[68:71], v202 offset:0
  v_add_f32 v118, v118, v154
  v_add_f32 v119, v119, v155
  v_cvt_pk_bf16_f32 v160, v112, v113
  v_cvt_pk_bf16_f32 v161, v114, v115
  v_cvt_pk_bf16_f32 v162, v116, v117
  v_mfma_f32_32x32x16_f16 v[16:31], v[92:95], v[84:87], v[16:31]
  ds_read_b128 v[76:79], v191 offset:2464
  v_cvt_pk_bf16_f32 v163, v118, v119
  v_pk_min_u16 v160, v160, s43
  v_pk_min_u16 v161, v161, s43
  v_pk_min_u16 v162, v162, s43
  v_pk_min_u16 v163, v163, s43
  s_waitcnt lgkmcnt(4)
  v_mfma_f32_32x32x16_f16 v[16:31], v[96:99], v[104:107], v[16:31]
  ds_read_b128 v[80:83], v191 offset:384
  ds_read_b128 v[88:91], v192 offset:112
  s_lshl_b32 s31, s40, 12
  s_setprio 3
  buffer_store_dwordx4 v[160:163], v254, s[24:27], s31 offen sc1
  s_setprio 3
  v_mfma_f32_32x32x16_f16 v[0:15], v[96:99], v[100:103], v[0:15]
  ds_read_b128 v[84:87], v202 offset:32
  v_mfma_f32_32x32x16_f16 v[16:31], v[108:111], v[100:103], v[16:31]
  ds_read_b128 v[92:95], v191 offset:2432
  s_waitcnt lgkmcnt(4)
  v_mfma_f32_32x32x16_f16 v[16:31], v[64:67], v[72:75], v[16:31]
  ds_read_b128 v[96:99], v191 offset:480
  ds_read_b128 v[104:107], v192 offset:0
  v_mfma_f32_32x32x16_f16 v[0:15], v[64:67], v[68:71], v[0:15]
  ds_read_b128 v[100:103], v203 offset:0
  v_mfma_f32_32x32x16_f16 v[16:31], v[76:79], v[68:71], v[16:31]
  ds_read_b128 v[108:111], v191 offset:2528
  s_waitcnt lgkmcnt(4)
  v_mfma_f32_32x32x16_f16 v[16:31], v[80:83], v[88:91], v[16:31]
  ds_read_b128 v[64:67], v191 offset:448
  ds_read_b128 v[72:75], v192 offset:32
  v_mfma_f32_32x32x16_f16 v[0:15], v[80:83], v[84:87], v[0:15]
  ds_read_b128 v[68:71], v203 offset:32
  v_mfma_f32_32x32x16_f16 v[16:31], v[92:95], v[84:87], v[16:31]
  ds_read_b128 v[76:79], v191 offset:2496
  s_waitcnt lgkmcnt(4)
  v_mfma_f32_32x32x16_f16 v[16:31], v[96:99], v[104:107], v[16:31]
  v_mfma_f32_32x32x16_f16 v[0:15], v[96:99], v[100:103], v[0:15]
  v_mfma_f32_32x32x16_f16 v[16:31], v[108:111], v[100:103], v[16:31]
  s_waitcnt lgkmcnt(0)
  v_mfma_f32_32x32x16_f16 v[16:31], v[64:67], v[72:75], v[16:31]
  v_mfma_f32_32x32x16_f16 v[0:15], v[64:67], v[68:71], v[0:15]
  v_mfma_f32_32x32x16_f16 v[16:31], v[76:79], v[68:71], v[16:31]
  s_barrier
  s_setprio 3
  ds_read_b128 v[144:147], v195 offset:34896
  s_nop 7
  ds_write_b128 v193, v[0:3] offset:0
  ds_write_b128 v193, v[4:7] offset:1088
  ds_write_b128 v193, v[8:11] offset:2176
  ds_write_b128 v193, v[12:15] offset:3264
  ds_write_b128 v193, v[16:19] offset:4352
  ds_write_b128 v193, v[20:23] offset:5440
  ds_write_b128 v193, v[24:27] offset:6528
  ds_write_b128 v193, v[28:31] offset:7616
  s_waitcnt lgkmcnt(0)
  s_barrier
  ds_read_b128 v[112:115], v194 offset:0
  ds_read_b128 v[116:119], v194 offset:512
  ds_read_b128 v[120:123], v194 offset:8704
  ds_read_b128 v[124:127], v194 offset:9216
  ds_read_b128 v[128:131], v194 offset:17408
  ds_read_b128 v[132:135], v194 offset:17920
  ds_read_b128 v[136:139], v194 offset:26112
  ds_read_b128 v[140:143], v194 offset:26624
  v_fma_mix_f32 v148, v144, v253, 0 op_sel:[0,0,0] op_sel_hi:[1,0,0]
  v_fma_mix_f32 v149, v144, v253, 0 op_sel:[1,0,0] op_sel_hi:[1,0,0]
  v_fma_mix_f32 v150, v145, v253, 0 op_sel:[0,0,0] op_sel_hi:[1,0,0]
  v_fma_mix_f32 v151, v145, v253, 0 op_sel:[1,0,0] op_sel_hi:[1,0,0]
  v_fma_mix_f32 v152, v146, v253, 0 op_sel:[0,0,0] op_sel_hi:[1,0,0]
  v_fma_mix_f32 v153, v146, v253, 0 op_sel:[1,0,0] op_sel_hi:[1,0,0]
  v_fma_mix_f32 v154, v147, v253, 0 op_sel:[0,0,0] op_sel_hi:[1,0,0]
  v_fma_mix_f32 v155, v147, v253, 0 op_sel:[1,0,0] op_sel_hi:[1,0,0]
  v_cvt_pk_bf16_f32 v156, v148, v149
  v_cvt_pk_bf16_f32 v157, v150, v151
  v_cvt_pk_bf16_f32 v158, v152, v153
  v_cvt_pk_bf16_f32 v159, v154, v155
  v_lshlrev_b32 v148, 16, v156
  v_and_b32 v149, 0xffff0000, v156
  v_lshlrev_b32 v150, 16, v157
  v_and_b32 v151, 0xffff0000, v157
  v_lshlrev_b32 v152, 16, v158
  v_and_b32 v153, 0xffff0000, v158
  v_lshlrev_b32 v154, 16, v159
  v_and_b32 v155, 0xffff0000, v159
  s_waitcnt lgkmcnt(0)
  v_add_f32 v112, v112, v120
  v_add_f32 v113, v113, v121
  v_add_f32 v114, v114, v122
  v_add_f32 v115, v115, v123
  v_add_f32 v116, v116, v124
  v_add_f32 v117, v117, v125
  v_add_f32 v118, v118, v126
  v_add_f32 v119, v119, v127
  v_add_f32 v128, v128, v136
  v_add_f32 v129, v129, v137
  v_add_f32 v130, v130, v138
  v_add_f32 v131, v131, v139
  v_add_f32 v132, v132, v140
  v_add_f32 v133, v133, v141
  v_add_f32 v134, v134, v142
  v_add_f32 v135, v135, v143
  v_add_f32 v112, v112, v128
  v_add_f32 v113, v113, v129
  v_add_f32 v114, v114, v130
  v_add_f32 v115, v115, v131
  v_add_f32 v116, v116, v132
  v_add_f32 v117, v117, v133
  v_add_f32 v118, v118, v134
  v_add_f32 v119, v119, v135
  v_mul_f32 v112, v112, v252
  v_mul_f32 v113, v113, v252
  v_mul_f32 v114, v114, v252
  v_mul_f32 v115, v115, v252
  v_mul_f32 v116, v116, v252
  v_mul_f32 v117, v117, v252
  v_mul_f32 v118, v118, v252
  v_mul_f32 v119, v119, v252
  v_cvt_pk_bf16_f32 v156, v112, v113
  v_cvt_pk_bf16_f32 v157, v114, v115
  v_cvt_pk_bf16_f32 v158, v116, v117
  v_cvt_pk_bf16_f32 v159, v118, v119
  v_lshlrev_b32 v112, 16, v156
  v_and_b32 v113, 0xffff0000, v156
  v_lshlrev_b32 v114, 16, v157
  v_and_b32 v115, 0xffff0000, v157
  v_lshlrev_b32 v116, 16, v158
  v_and_b32 v117, 0xffff0000, v158
  v_lshlrev_b32 v118, 16, v159
  v_and_b32 v119, 0xffff0000, v159
  v_add_f32 v112, v112, v148
  v_add_f32 v113, v113, v149
  v_add_f32 v114, v114, v150
  v_add_f32 v115, v115, v151
  v_add_f32 v116, v116, v152
  v_add_f32 v117, v117, v153
  v_add_f32 v118, v118, v154
  v_add_f32 v119, v119, v155
  v_cvt_pk_bf16_f32 v160, v112, v113
  v_cvt_pk_bf16_f32 v161, v114, v115
  v_cvt_pk_bf16_f32 v162, v116, v117
  v_cvt_pk_bf16_f32 v163, v118, v119
  v_pk_min_u16 v160, v160, s43
  v_pk_min_u16 v161, v161, s43
  v_pk_min_u16 v162, v162, s43
  v_pk_min_u16 v163, v163, s43
  s_lshl_b32 s31, s41, 12
  s_setprio 3
  buffer_store_dwordx4 v[160:163], v254, s[24:27], s31 offen sc1
  s_setprio 3
  s_endpgm
conv_two:
  ds_read_b128 v[64:67], v207 offset:32
  ds_read_b128 v[72:75], v208 offset:560
  ds_read_b128 v[68:71], v212 offset:0
  ds_read_b128 v[76:79], v207 offset:2080
  ds_read_b128 v[80:83], v207 offset:0
  ds_read_b128 v[88:91], v208 offset:592
  ds_read_b128 v[84:87], v212 offset:32
  ds_read_b128 v[92:95], v207 offset:2048
  s_waitcnt lgkmcnt(4)
  v_mfma_f32_32x32x16_f16 v[48:63], v[64:67], v[72:75], 0
  ds_read_b128 v[96:99], v207 offset:96
  ds_read_b128 v[104:107], v208 offset:480
  v_mfma_f32_32x32x16_f16 v[32:47], v[64:67], v[68:71], 0
  ds_read_b128 v[100:103], v213 offset:0
  ds_read_b128 v[144:147], v195 offset:34896
  v_mfma_f32_32x32x16_f16 v[48:63], v[76:79], v[68:71], v[48:63]
  ds_read_b128 v[108:111], v207 offset:2144
  ds_write_b128 v193, v[0:3] offset:0
  s_waitcnt lgkmcnt(6)
  v_mfma_f32_32x32x16_f16 v[48:63], v[80:83], v[88:91], v[48:63]
  ds_read_b128 v[64:67], v207 offset:64
  ds_read_b128 v[72:75], v208 offset:512
  ds_write_b128 v193, v[4:7] offset:1088
  v_mfma_f32_32x32x16_f16 v[32:47], v[80:83], v[84:87], v[32:47]
  ds_read_b128 v[68:71], v213 offset:32
  ds_write_b128 v193, v[8:11] offset:2176
  v_mfma_f32_32x32x16_f16 v[48:63], v[92:95], v[84:87], v[48:63]
  ds_read_b128 v[76:79], v207 offset:2112
  ds_write_b128 v193, v[12:15] offset:3264
  s_waitcnt lgkmcnt(8)
  v_mfma_f32_32x32x16_f16 v[48:63], v[96:99], v[104:107], v[48:63]
  ds_read_b128 v[80:83], v207 offset:160
  ds_read_b128 v[88:91], v208 offset:400
  ds_write_b128 v193, v[16:19] offset:4352
  v_mfma_f32_32x32x16_f16 v[32:47], v[96:99], v[100:103], v[32:47]
  ds_read_b128 v[84:87], v214 offset:0
  ds_write_b128 v193, v[20:23] offset:5440
  v_mfma_f32_32x32x16_f16 v[48:63], v[108:111], v[100:103], v[48:63]
  ds_read_b128 v[92:95], v207 offset:2208
  ds_write_b128 v193, v[24:27] offset:6528
  s_waitcnt lgkmcnt(8)
  v_mfma_f32_32x32x16_f16 v[48:63], v[64:67], v[72:75], v[48:63]
  ds_read_b128 v[96:99], v207 offset:128
  ds_read_b128 v[104:107], v208 offset:432
  ds_write_b128 v193, v[28:31] offset:7616
  v_mfma_f32_32x32x16_f16 v[32:47], v[64:67], v[68:71], v[32:47]
  ds_read_b128 v[100:103], v214 offset:32
  v_mfma_f32_32x32x16_f16 v[48:63], v[76:79], v[68:71], v[48:63]
  ds_read_b128 v[108:111], v207 offset:2176
  s_waitcnt lgkmcnt(6)
  v_mfma_f32_32x32x16_f16 v[48:63], v[80:83], v[88:91], v[48:63]
  ds_read_b128 v[64:67], v207 offset:224
  ds_read_b128 v[72:75], v208 offset:320
  v_mfma_f32_32x32x16_f16 v[32:47], v[80:83], v[84:87], v[32:47]
  ds_read_b128 v[68:71], v215 offset:0
  s_waitcnt lgkmcnt(0)
  s_barrier
  v_mfma_f32_32x32x16_f16 v[48:63], v[92:95], v[84:87], v[48:63]
  ds_read_b128 v[76:79], v207 offset:2272
  ds_read_b128 v[112:115], v194 offset:0
  ds_read_b128 v[116:119], v194 offset:512
  ds_read_b128 v[120:123], v194 offset:8704
  ds_read_b128 v[124:127], v194 offset:9216
  ds_read_b128 v[128:131], v194 offset:17408
  v_mfma_f32_32x32x16_f16 v[48:63], v[96:99], v[104:107], v[48:63]
  ds_read_b128 v[80:83], v207 offset:192
  ds_read_b128 v[88:91], v208 offset:352
  ds_read_b128 v[132:135], v194 offset:17920
  ds_read_b128 v[136:139], v194 offset:26112
  ds_read_b128 v[140:143], v194 offset:26624
  v_fma_mix_f32 v148, v144, v249, 0 op_sel:[0,0,0] op_sel_hi:[1,0,0]
  v_fma_mix_f32 v149, v144, v249, 0 op_sel:[1,0,0] op_sel_hi:[1,0,0]
  v_mfma_f32_32x32x16_f16 v[32:47], v[96:99], v[100:103], v[32:47]
  ds_read_b128 v[84:87], v215 offset:32
  v_fma_mix_f32 v150, v145, v249, 0 op_sel:[0,0,0] op_sel_hi:[1,0,0]
  v_fma_mix_f32 v151, v145, v249, 0 op_sel:[1,0,0] op_sel_hi:[1,0,0]
  v_fma_mix_f32 v152, v146, v249, 0 op_sel:[0,0,0] op_sel_hi:[1,0,0]
  v_fma_mix_f32 v153, v146, v249, 0 op_sel:[1,0,0] op_sel_hi:[1,0,0]
  v_fma_mix_f32 v154, v147, v249, 0 op_sel:[0,0,0] op_sel_hi:[1,0,0]
  v_mfma_f32_32x32x16_f16 v[48:63], v[108:111], v[100:103], v[48:63]
  ds_read_b128 v[92:95], v207 offset:2240
  v_fma_mix_f32 v155, v147, v249, 0 op_sel:[1,0,0] op_sel_hi:[1,0,0]
  v_cvt_pk_bf16_f32 v156, v148, v149
  v_cvt_pk_bf16_f32 v157, v150, v151
  v_cvt_pk_bf16_f32 v158, v152, v153
  v_cvt_pk_bf16_f32 v159, v154, v155
  s_waitcnt lgkmcnt(12)
  v_mfma_f32_32x32x16_f16 v[48:63], v[64:67], v[72:75], v[48:63]
  ds_read_b128 v[96:99], v207 offset:288
  ds_read_b128 v[104:107], v208 offset:240
  v_lshlrev_b32 v148, 16, v156
  v_and_b32 v149, 0xffff0000, v156
  v_lshlrev_b32 v150, 16, v157
  v_and_b32 v151, 0xffff0000, v157
  v_lshlrev_b32 v152, 16, v158
  v_mfma_f32_32x32x16_f16 v[32:47], v[64:67], v[68:71], v[32:47]
  ds_read_b128 v[100:103], v216 offset:0
  v_and_b32 v153, 0xffff0000, v158
  v_lshlrev_b32 v154, 16, v159
  v_and_b32 v155, 0xffff0000, v159
  s_waitcnt lgkmcnt(5)
  v_mfma_f32_32x32x16_f16 v[48:63], v[76:79], v[68:71], v[48:63]
  ds_read_b128 v[108:111], v207 offset:2336
  s_waitcnt lgkmcnt(4)
  v_mfma_f32_32x32x16_f16 v[48:63], v[80:83], v[88:91], v[48:63]
  ds_read_b128 v[64:67], v207 offset:256
  ds_read_b128 v[72:75], v208 offset:272
  v_add_f32 v112, v112, v120
  v_add_f32 v113, v113, v121
  v_add_f32 v114, v114, v122
  v_add_f32 v115, v115, v123
  v_add_f32 v116, v116, v124
  v_mfma_f32_32x32x16_f16 v[32:47], v[80:83], v[84:87], v[32:47]
  ds_read_b128 v[68:71], v216 offset:32
  v_add_f32 v117, v117, v125
  v_add_f32 v118, v118, v126
  v_add_f32 v119, v119, v127
  v_add_f32 v128, v128, v136
  v_add_f32 v129, v129, v137
  v_mfma_f32_32x32x16_f16 v[48:63], v[92:95], v[84:87], v[48:63]
  ds_read_b128 v[76:79], v207 offset:2304
  v_add_f32 v130, v130, v138
  v_add_f32 v131, v131, v139
  v_add_f32 v132, v132, v140
  v_add_f32 v133, v133, v141
  v_add_f32 v134, v134, v142
  s_waitcnt lgkmcnt(4)
  v_mfma_f32_32x32x16_f16 v[48:63], v[96:99], v[104:107], v[48:63]
  ds_read_b128 v[80:83], v207 offset:352
  ds_read_b128 v[88:91], v208 offset:160
  v_add_f32 v135, v135, v143
  v_add_f32 v112, v112, v128
  v_add_f32 v113, v113, v129
  v_add_f32 v114, v114, v130
  v_add_f32 v115, v115, v131
  v_mfma_f32_32x32x16_f16 v[32:47], v[96:99], v[100:103], v[32:47]
  ds_read_b128 v[84:87], v217 offset:0
  v_add_f32 v116, v116, v132
  v_add_f32 v117, v117, v133
  v_add_f32 v118, v118, v134
  v_add_f32 v119, v119, v135
  v_mul_f32 v112, v112, v248
  v_mfma_f32_32x32x16_f16 v[48:63], v[108:111], v[100:103], v[48:63]
  ds_read_b128 v[92:95], v207 offset:2400
  v_mul_f32 v113, v113, v248
  v_mul_f32 v114, v114, v248
  v_mul_f32 v115, v115, v248
  v_mul_f32 v116, v116, v248
  v_mul_f32 v117, v117, v248
  s_waitcnt lgkmcnt(4)
  v_mfma_f32_32x32x16_f16 v[48:63], v[64:67], v[72:75], v[48:63]
  ds_read_b128 v[96:99], v207 offset:320
  ds_read_b128 v[104:107], v208 offset:192
  v_mul_f32 v118, v118, v248
  v_mul_f32 v119, v119, v248
  v_cvt_pk_bf16_f32 v156, v112, v113
  v_cvt_pk_bf16_f32 v157, v114, v115
  v_cvt_pk_bf16_f32 v158, v116, v117
  v_mfma_f32_32x32x16_f16 v[32:47], v[64:67], v[68:71], v[32:47]
  ds_read_b128 v[100:103], v217 offset:32
  v_cvt_pk_bf16_f32 v159, v118, v119
  v_lshlrev_b32 v112, 16, v156
  v_and_b32 v113, 0xffff0000, v156
  v_lshlrev_b32 v114, 16, v157
  v_and_b32 v115, 0xffff0000, v157
  v_mfma_f32_32x32x16_f16 v[48:63], v[76:79], v[68:71], v[48:63]
  ds_read_b128 v[108:111], v207 offset:2368
  v_lshlrev_b32 v116, 16, v158
  v_and_b32 v117, 0xffff0000, v158
  v_lshlrev_b32 v118, 16, v159
  v_and_b32 v119, 0xffff0000, v159
  v_add_f32 v112, v112, v148
  s_waitcnt lgkmcnt(4)
  v_mfma_f32_32x32x16_f16 v[48:63], v[80:83], v[88:91], v[48:63]
  ds_read_b128 v[64:67], v207 offset:416
  ds_read_b128 v[72:75], v208 offset:80
  v_add_f32 v113, v113, v149
  v_add_f32 v114, v114, v150
  v_add_f32 v115, v115, v151
  v_add_f32 v116, v116, v152
  v_add_f32 v117, v117, v153
  v_mfma_f32_32x32x16_f16 v[32:47], v[80:83], v[84:87], v[32:47]
  ds_read_b128 v[68:71], v218 offset:0
  v_add_f32 v118, v118, v154
  v_add_f32 v119, v119, v155
  v_cvt_pk_bf16_f32 v160, v112, v113
  v_cvt_pk_bf16_f32 v161, v114, v115
  v_cvt_pk_bf16_f32 v162, v116, v117
  v_mfma_f32_32x32x16_f16 v[48:63], v[92:95], v[84:87], v[48:63]
  ds_read_b128 v[76:79], v207 offset:2464
  v_cvt_pk_bf16_f32 v163, v118, v119
  v_pk_min_u16 v160, v160, s43
  v_pk_min_u16 v161, v161, s43
  v_pk_min_u16 v162, v162, s43
  v_pk_min_u16 v163, v163, s43
  s_waitcnt lgkmcnt(4)
  v_mfma_f32_32x32x16_f16 v[48:63], v[96:99], v[104:107], v[48:63]
  ds_read_b128 v[80:83], v207 offset:384
  ds_read_b128 v[88:91], v208 offset:112
  s_lshl_b32 s31, s2, 12
  s_setprio 3
  buffer_store_dwordx4 v[160:163], v254, s[24:27], s31 offen sc1
  s_setprio 3
  v_mfma_f32_32x32x16_f16 v[32:47], v[96:99], v[100:103], v[32:47]
  ds_read_b128 v[84:87], v218 offset:32
  v_mfma_f32_32x32x16_f16 v[48:63], v[108:111], v[100:103], v[48:63]
  ds_read_b128 v[92:95], v207 offset:2432
  s_waitcnt lgkmcnt(4)
  v_mfma_f32_32x32x16_f16 v[48:63], v[64:67], v[72:75], v[48:63]
  ds_read_b128 v[96:99], v207 offset:480
  ds_read_b128 v[104:107], v208 offset:0
  v_mfma_f32_32x32x16_f16 v[32:47], v[64:67], v[68:71], v[32:47]
  ds_read_b128 v[100:103], v219 offset:0
  v_mfma_f32_32x32x16_f16 v[48:63], v[76:79], v[68:71], v[48:63]
  ds_read_b128 v[108:111], v207 offset:2528
  s_waitcnt lgkmcnt(4)
  v_mfma_f32_32x32x16_f16 v[48:63], v[80:83], v[88:91], v[48:63]
  ds_read_b128 v[64:67], v207 offset:448
  ds_read_b128 v[72:75], v208 offset:32
  v_mfma_f32_32x32x16_f16 v[32:47], v[80:83], v[84:87], v[32:47]
  ds_read_b128 v[68:71], v219 offset:32
  v_mfma_f32_32x32x16_f16 v[48:63], v[92:95], v[84:87], v[48:63]
  ds_read_b128 v[76:79], v207 offset:2496
  s_waitcnt lgkmcnt(4)
  v_mfma_f32_32x32x16_f16 v[48:63], v[96:99], v[104:107], v[48:63]
  v_mfma_f32_32x32x16_f16 v[32:47], v[96:99], v[100:103], v[32:47]
  v_mfma_f32_32x32x16_f16 v[48:63], v[108:111], v[100:103], v[48:63]
  s_waitcnt lgkmcnt(0)
  v_mfma_f32_32x32x16_f16 v[48:63], v[64:67], v[72:75], v[48:63]
  v_mfma_f32_32x32x16_f16 v[32:47], v[64:67], v[68:71], v[32:47]
  v_mfma_f32_32x32x16_f16 v[48:63], v[76:79], v[68:71], v[48:63]
  s_barrier
  s_setprio 3
  ds_read_b128 v[144:147], v211 offset:34896
  s_nop 7
  ds_write_b128 v209, v[32:35] offset:0
  ds_write_b128 v209, v[36:39] offset:1088
  ds_write_b128 v209, v[40:43] offset:2176
  ds_write_b128 v209, v[44:47] offset:3264
  ds_write_b128 v209, v[48:51] offset:4352
  ds_write_b128 v209, v[52:55] offset:5440
  ds_write_b128 v209, v[56:59] offset:6528
  ds_write_b128 v209, v[60:63] offset:7616
  s_waitcnt lgkmcnt(0)
  s_barrier
  ds_read_b128 v[112:115], v210 offset:0
  ds_read_b128 v[116:119], v210 offset:512
  ds_read_b128 v[120:123], v210 offset:8704
  ds_read_b128 v[124:127], v210 offset:9216
  ds_read_b128 v[128:131], v210 offset:17408
  ds_read_b128 v[132:135], v210 offset:17920
  ds_read_b128 v[136:139], v210 offset:26112
  ds_read_b128 v[140:143], v210 offset:26624
  v_fma_mix_f32 v148, v144, v251, 0 op_sel:[0,0,0] op_sel_hi:[1,0,0]
  v_fma_mix_f32 v149, v144, v251, 0 op_sel:[1,0,0] op_sel_hi:[1,0,0]
  v_fma_mix_f32 v150, v145, v251, 0 op_sel:[0,0,0] op_sel_hi:[1,0,0]
  v_fma_mix_f32 v151, v145, v251, 0 op_sel:[1,0,0] op_sel_hi:[1,0,0]
  v_fma_mix_f32 v152, v146, v251, 0 op_sel:[0,0,0] op_sel_hi:[1,0,0]
  v_fma_mix_f32 v153, v146, v251, 0 op_sel:[1,0,0] op_sel_hi:[1,0,0]
  v_fma_mix_f32 v154, v147, v251, 0 op_sel:[0,0,0] op_sel_hi:[1,0,0]
  v_fma_mix_f32 v155, v147, v251, 0 op_sel:[1,0,0] op_sel_hi:[1,0,0]
  v_cvt_pk_bf16_f32 v156, v148, v149
  v_cvt_pk_bf16_f32 v157, v150, v151
  v_cvt_pk_bf16_f32 v158, v152, v153
  v_cvt_pk_bf16_f32 v159, v154, v155
  v_lshlrev_b32 v148, 16, v156
  v_and_b32 v149, 0xffff0000, v156
  v_lshlrev_b32 v150, 16, v157
  v_and_b32 v151, 0xffff0000, v157
  v_lshlrev_b32 v152, 16, v158
  v_and_b32 v153, 0xffff0000, v158
  v_lshlrev_b32 v154, 16, v159
  v_and_b32 v155, 0xffff0000, v159
  s_waitcnt lgkmcnt(0)
  v_add_f32 v112, v112, v120
  v_add_f32 v113, v113, v121
  v_add_f32 v114, v114, v122
  v_add_f32 v115, v115, v123
  v_add_f32 v116, v116, v124
  v_add_f32 v117, v117, v125
  v_add_f32 v118, v118, v126
  v_add_f32 v119, v119, v127
  v_add_f32 v128, v128, v136
  v_add_f32 v129, v129, v137
  v_add_f32 v130, v130, v138
  v_add_f32 v131, v131, v139
  v_add_f32 v132, v132, v140
  v_add_f32 v133, v133, v141
  v_add_f32 v134, v134, v142
  v_add_f32 v135, v135, v143
  v_add_f32 v112, v112, v128
  v_add_f32 v113, v113, v129
  v_add_f32 v114, v114, v130
  v_add_f32 v115, v115, v131
  v_add_f32 v116, v116, v132
  v_add_f32 v117, v117, v133
  v_add_f32 v118, v118, v134
  v_add_f32 v119, v119, v135
  v_mul_f32 v112, v112, v250
  v_mul_f32 v113, v113, v250
  v_mul_f32 v114, v114, v250
  v_mul_f32 v115, v115, v250
  v_mul_f32 v116, v116, v250
  v_mul_f32 v117, v117, v250
  v_mul_f32 v118, v118, v250
  v_mul_f32 v119, v119, v250
  v_cvt_pk_bf16_f32 v156, v112, v113
  v_cvt_pk_bf16_f32 v157, v114, v115
  v_cvt_pk_bf16_f32 v158, v116, v117
  v_cvt_pk_bf16_f32 v159, v118, v119
  v_lshlrev_b32 v112, 16, v156
  v_and_b32 v113, 0xffff0000, v156
  v_lshlrev_b32 v114, 16, v157
  v_and_b32 v115, 0xffff0000, v157
  v_lshlrev_b32 v116, 16, v158
  v_and_b32 v117, 0xffff0000, v158
  v_lshlrev_b32 v118, 16, v159
  v_and_b32 v119, 0xffff0000, v159
  v_add_f32 v112, v112, v148
  v_add_f32 v113, v113, v149
  v_add_f32 v114, v114, v150
  v_add_f32 v115, v115, v151
  v_add_f32 v116, v116, v152
  v_add_f32 v117, v117, v153
  v_add_f32 v118, v118, v154
  v_add_f32 v119, v119, v155
  v_cvt_pk_bf16_f32 v160, v112, v113
  v_cvt_pk_bf16_f32 v161, v114, v115
  v_cvt_pk_bf16_f32 v162, v116, v117
  v_cvt_pk_bf16_f32 v163, v118, v119
  v_pk_min_u16 v160, v160, s43
  v_pk_min_u16 v161, v161, s43
  v_pk_min_u16 v162, v162, s43
  v_pk_min_u16 v163, v163, s43
  s_lshl_b32 s31, s40, 12
  s_setprio 3
  buffer_store_dwordx4 v[160:163], v254, s[24:27], s31 offen sc1
  s_setprio 3
  s_endpgm
L_g2:
  s_setprio 2
  s_load_dwordx2 s[4:5], s[0:1], 120
  s_load_dwordx2 s[6:7], s[0:1], 0
  s_load_dwordx2 s[28:29], s[0:1], 104
  s_and_b32 s3, s2, 7
  s_lshr_b32 s50, s2, 3
  s_and_b32 s51, s3, 3
  s_lshl_b32 s51, s51, 3
  s_and_b32 s52, s50, 7
  s_add_u32 s51, s51, s52
  s_lshr_b32 s52, s3, 2
  s_lshl_b32 s52, s52, 2
  s_lshr_b32 s53, s50, 3
  s_add_u32 s52, s52, s53
  v_and_b32 v250, 63, v0
  v_lshrrev_b32 v251, 6, v0
  s_nop 0
  v_readfirstlane_b32 s53, v251
  v_lshlrev_b32 v252, 4, v250
  s_mul_i32 s34, s51, 221184
  s_mul_i32 s35, s52, 276480
  s_add_u32 s36, s53, 0
  s_and_b32 s36, s36, 3
  s_mul_i32 s36, s36, 55296
  s_add_u32 s36, s36, s34
  v_add_u32 v224, s36, v252
  s_add_u32 s36, s53, 1
  s_and_b32 s36, s36, 3
  s_mul_i32 s36, s36, 55296
  s_add_u32 s36, s36, s34
  v_add_u32 v225, s36, v252
  s_add_u32 s36, s53, 2
  s_and_b32 s36, s36, 3
  s_mul_i32 s36, s36, 55296
  s_add_u32 s36, s36, s34
  v_add_u32 v226, s36, v252
  s_add_u32 s36, s53, 3
  s_and_b32 s36, s36, 3
  s_mul_i32 s36, s36, 55296
  s_add_u32 s36, s36, s34
  v_add_u32 v227, s36, v252
  s_add_u32 s36, s35, 0
  v_add_u32 v228, s36, v252
  s_add_u32 s36, s35, 55296
  v_add_u32 v229, s36, v252
  s_add_u32 s36, s35, 110592
  v_add_u32 v230, s36, v252
  s_add_u32 s36, s35, 165888
  v_add_u32 v231, s36, v252
  s_add_u32 s36, s35, 221184
  v_add_u32 v232, s36, v252
  s_mul_i32 s36, s53, 14336
  s_waitcnt lgkmcnt(0)
  s_mov_b32 s8, s4
  s_mov_b32 s9, s5
  s_mov_b32 s10, 7077888
  s_mov_b32 s11, 0x00020000
  s_add_u32 s12, s4, 7340032
  s_addc_u32 s13, s5, 0
  s_mov_b32 s14, 2211840
  s_mov_b32 s15, 0x00020000
  buffer_load_dwordx4 v[96:99], v228, s[12:15], s36 offen
  buffer_load_dwordx4 v[100:103], v229, s[12:15], s36 offen
  buffer_load_dwordx4 v[104:107], v230, s[12:15], s36 offen
  buffer_load_dwordx4 v[108:111], v231, s[12:15], s36 offen
  buffer_load_dwordx4 v[112:115], v232, s[12:15], s36 offen
  buffer_load_dwordx4 v[80:83], v224, s[8:11], s36 offen
  buffer_load_dwordx4 v[84:87], v225, s[8:11], s36 offen
  buffer_load_dwordx4 v[88:91], v226, s[8:11], s36 offen
  buffer_load_dwordx4 v[92:95], v227, s[8:11], s36 offen
  s_add_u32 s36, s36, 1024
  buffer_load_dwordx4 v[132:135], v228, s[12:15], s36 offen
  buffer_load_dwordx4 v[136:139], v229, s[12:15], s36 offen
  buffer_load_dwordx4 v[140:143], v230, s[12:15], s36 offen
  buffer_load_dwordx4 v[144:147], v231, s[12:15], s36 offen
  buffer_load_dwordx4 v[148:151], v232, s[12:15], s36 offen
  buffer_load_dwordx4 v[116:119], v224, s[8:11], s36 offen
  buffer_load_dwordx4 v[120:123], v225, s[8:11], s36 offen
  buffer_load_dwordx4 v[124:127], v226, s[8:11], s36 offen
  buffer_load_dwordx4 v[128:131], v227, s[8:11], s36 offen
  s_add_u32 s36, s36, 1024
  s_add_u32 s16, s4, 17825792
  s_addc_u32 s17, s5, 0
  s_mov_b32 s18, 2621440
  s_mov_b32 s19, 0x00020000
  s_mov_b32 s20, s6
  s_mov_b32 s21, s7
  s_mov_b32 s22, 2621440
  s_mov_b32 s23, 0x00020000
  s_mov_b32 s24, s28
  s_mov_b32 s25, s29
  s_mov_b32 s26, 2621440
  s_mov_b32 s27, 0x00020000
  s_movk_i32 s40, 3277
  s_lshl_b32 s41, s51, 2
  s_add_u32 s41, s41, s53
  s_mul_i32 s41, s41, 20480
  s_mul_i32 s42, s52, 160
  s_add_u32 s41, s41, s42
  v_add_u32 v253, 0, v250
  v_mul_u32_u24 v254, s40, v253
  v_lshrrev_b32 v254, 16, v254
  v_mul_u32_u24 v255, 20, v254
  v_sub_u32 v253, v253, v255
  v_mul_u32_u24 v244, 1280, v254
  v_lshl_add_u32 v244, v253, 3, v244
  v_add_u32 v253, 64, v250
  v_mul_u32_u24 v254, s40, v253
  v_lshrrev_b32 v254, 16, v254
  v_mul_u32_u24 v255, 20, v254
  v_sub_u32 v253, v253, v255
  v_mul_u32_u24 v245, 1280, v254
  v_lshl_add_u32 v245, v253, 3, v245
  v_add_u32 v253, 128, v250
  v_mul_u32_u24 v254, s40, v253
  v_lshrrev_b32 v254, 16, v254
  v_mul_u32_u24 v255, 20, v254
  v_sub_u32 v253, v253, v255
  v_mul_u32_u24 v246, 1280, v254
  v_lshl_add_u32 v246, v253, 3, v246
  v_add_u32 v253, 192, v250
  v_mul_u32_u24 v254, s40, v253
  v_lshrrev_b32 v254, 16, v254
  v_mul_u32_u24 v255, 20, v254
  v_sub_u32 v253, v253, v255
  v_mul_u32_u24 v247, 1280, v254
  v_lshl_add_u32 v247, v253, 3, v247
  v_add_u32 v253, 256, v250
  v_mul_u32_u24 v254, s40, v253
  v_lshrrev_b32 v254, 16, v254
  v_mul_u32_u24 v255, 20, v254
  v_sub_u32 v253, v253, v255
  v_mul_u32_u24 v248, 1280, v254
  v_lshl_add_u32 v248, v253, 3, v248
  v_lshrrev_b32 v253, 1, v250
  v_and_b32 v254, 1, v250
  v_lshlrev_b32 v249, 12, v253
  v_lshl_add_u32 v249, v254, 4, v249
  s_mul_i32 s38, s52, 80
  s_lshl_b32 s38, s38, 12
  s_lshl_b32 s39, s51, 7
  s_add_u32 s38, s38, s39
  s_lshl_b32 s39, s53, 5
  s_add_u32 s38, s38, s39
  s_mul_i32 s39, s53, 3072
  s_add_u32 s56, s38, 131072
  s_add_u32 s57, s38, 262144
  buffer_load_dwordx4 v[168:171], v228, s[12:15], s36 offen
  buffer_load_dwordx4 v[172:175], v229, s[12:15], s36 offen
  buffer_load_dwordx4 v[176:179], v230, s[12:15], s36 offen
  buffer_load_dwordx4 v[180:183], v231, s[12:15], s36 offen
  buffer_load_dwordx4 v[184:187], v232, s[12:15], s36 offen
  buffer_load_dwordx4 v[152:155], v224, s[8:11], s36 offen
  buffer_load_dwordx4 v[156:159], v225, s[8:11], s36 offen
  buffer_load_dwordx4 v[160:163], v226, s[8:11], s36 offen
  buffer_load_dwordx4 v[164:167], v227, s[8:11], s36 offen
  s_add_u32 s36, s36, 1024
  s_waitcnt vmcnt(21)
  v_mfma_f32_16x16x32_bf16 v[0:3], v[96:99], v[80:83], 0
  v_mfma_f32_16x16x32_bf16 v[16:19], v[100:103], v[80:83], 0
  buffer_load_dwordx4 v[204:207], v228, s[12:15], s36 offen
  v_mfma_f32_16x16x32_bf16 v[32:35], v[104:107], v[80:83], 0
  v_mfma_f32_16x16x32_bf16 v[48:51], v[108:111], v[80:83], 0
  buffer_load_dwordx4 v[208:211], v229, s[12:15], s36 offen
  v_mfma_f32_16x16x32_bf16 v[64:67], v[112:115], v[80:83], 0
  s_waitcnt vmcnt(22)
  v_mfma_f32_16x16x32_bf16 v[4:7], v[96:99], v[84:87], 0
  buffer_load_dwordx4 v[212:215], v230, s[12:15], s36 offen
  v_mfma_f32_16x16x32_bf16 v[20:23], v[100:103], v[84:87], 0
  v_mfma_f32_16x16x32_bf16 v[36:39], v[104:107], v[84:87], 0
  buffer_load_dwordx4 v[216:219], v231, s[12:15], s36 offen
  v_mfma_f32_16x16x32_bf16 v[52:55], v[108:111], v[84:87], 0
  v_mfma_f32_16x16x32_bf16 v[68:71], v[112:115], v[84:87], 0
  buffer_load_dwordx4 v[220:223], v232, s[12:15], s36 offen
  s_waitcnt vmcnt(24)
  v_mfma_f32_16x16x32_bf16 v[8:11], v[96:99], v[88:91], 0
  v_mfma_f32_16x16x32_bf16 v[24:27], v[100:103], v[88:91], 0
  buffer_load_dwordx4 v[188:191], v224, s[8:11], s36 offen
  v_mfma_f32_16x16x32_bf16 v[40:43], v[104:107], v[88:91], 0
  v_mfma_f32_16x16x32_bf16 v[56:59], v[108:111], v[88:91], 0
  buffer_load_dwordx4 v[192:195], v225, s[8:11], s36 offen
  v_mfma_f32_16x16x32_bf16 v[72:75], v[112:115], v[88:91], 0
  s_waitcnt vmcnt(25)
  v_mfma_f32_16x16x32_bf16 v[12:15], v[96:99], v[92:95], 0
  buffer_load_dwordx4 v[196:199], v226, s[8:11], s36 offen
  v_mfma_f32_16x16x32_bf16 v[28:31], v[100:103], v[92:95], 0
  v_mfma_f32_16x16x32_bf16 v[44:47], v[104:107], v[92:95], 0
  buffer_load_dwordx4 v[200:203], v227, s[8:11], s36 offen
  s_add_u32 s36, s36, 1024
  v_mfma_f32_16x16x32_bf16 v[60:63], v[108:111], v[92:95], 0
  v_mfma_f32_16x16x32_bf16 v[76:79], v[112:115], v[92:95], 0
  s_waitcnt vmcnt(21)
  v_mfma_f32_16x16x32_bf16 v[0:3], v[132:135], v[116:119], v[0:3]
  v_mfma_f32_16x16x32_bf16 v[16:19], v[136:139], v[116:119], v[16:19]
  buffer_load_dwordx4 v[96:99], v228, s[12:15], s36 offen
  v_mfma_f32_16x16x32_bf16 v[32:35], v[140:143], v[116:119], v[32:35]
  v_mfma_f32_16x16x32_bf16 v[48:51], v[144:147], v[116:119], v[48:51]
  buffer_load_dwordx4 v[100:103], v229, s[12:15], s36 offen
  v_mfma_f32_16x16x32_bf16 v[64:67], v[148:151], v[116:119], v[64:67]
  s_waitcnt vmcnt(22)
  v_mfma_f32_16x16x32_bf16 v[4:7], v[132:135], v[120:123], v[4:7]
  buffer_load_dwordx4 v[104:107], v230, s[12:15], s36 offen
  v_mfma_f32_16x16x32_bf16 v[20:23], v[136:139], v[120:123], v[20:23]
  v_mfma_f32_16x16x32_bf16 v[36:39], v[140:143], v[120:123], v[36:39]
  buffer_load_dwordx4 v[108:111], v231, s[12:15], s36 offen
  v_mfma_f32_16x16x32_bf16 v[52:55], v[144:147], v[120:123], v[52:55]
  v_mfma_f32_16x16x32_bf16 v[68:71], v[148:151], v[120:123], v[68:71]
  buffer_load_dwordx4 v[112:115], v232, s[12:15], s36 offen
  s_waitcnt vmcnt(24)
  v_mfma_f32_16x16x32_bf16 v[8:11], v[132:135], v[124:127], v[8:11]
  v_mfma_f32_16x16x32_bf16 v[24:27], v[136:139], v[124:127], v[24:27]
  buffer_load_dwordx4 v[80:83], v224, s[8:11], s36 offen
  v_mfma_f32_16x16x32_bf16 v[40:43], v[140:143], v[124:127], v[40:43]
  v_mfma_f32_16x16x32_bf16 v[56:59], v[144:147], v[124:127], v[56:59]
  buffer_load_dwordx4 v[84:87], v225, s[8:11], s36 offen
  v_mfma_f32_16x16x32_bf16 v[72:75], v[148:151], v[124:127], v[72:75]
  s_waitcnt vmcnt(25)
  v_mfma_f32_16x16x32_bf16 v[12:15], v[132:135], v[128:131], v[12:15]
  buffer_load_dwordx4 v[88:91], v226, s[8:11], s36 offen
  v_mfma_f32_16x16x32_bf16 v[28:31], v[136:139], v[128:131], v[28:31]
  v_mfma_f32_16x16x32_bf16 v[44:47], v[140:143], v[128:131], v[44:47]
  buffer_load_dwordx4 v[92:95], v227, s[8:11], s36 offen
  s_add_u32 s36, s36, 1024
  v_mfma_f32_16x16x32_bf16 v[60:63], v[144:147], v[128:131], v[60:63]
  v_mfma_f32_16x16x32_bf16 v[76:79], v[148:151], v[128:131], v[76:79]
  s_waitcnt vmcnt(21)
  v_mfma_f32_16x16x32_bf16 v[0:3], v[168:171], v[152:155], v[0:3]
  v_mfma_f32_16x16x32_bf16 v[16:19], v[172:175], v[152:155], v[16:19]
  buffer_load_dwordx4 v[132:135], v228, s[12:15], s36 offen
  v_mfma_f32_16x16x32_bf16 v[32:35], v[176:179], v[152:155], v[32:35]
  v_mfma_f32_16x16x32_bf16 v[48:51], v[180:183], v[152:155], v[48:51]
  buffer_load_dwordx4 v[136:139], v229, s[12:15], s36 offen
  v_mfma_f32_16x16x32_bf16 v[64:67], v[184:187], v[152:155], v[64:67]
  s_waitcnt vmcnt(22)
  v_mfma_f32_16x16x32_bf16 v[4:7], v[168:171], v[156:159], v[4:7]
  buffer_load_dwordx4 v[140:143], v230, s[12:15], s36 offen
  v_mfma_f32_16x16x32_bf16 v[20:23], v[172:175], v[156:159], v[20:23]
  v_mfma_f32_16x16x32_bf16 v[36:39], v[176:179], v[156:159], v[36:39]
  buffer_load_dwordx4 v[144:147], v231, s[12:15], s36 offen
  v_mfma_f32_16x16x32_bf16 v[52:55], v[180:183], v[156:159], v[52:55]
  v_mfma_f32_16x16x32_bf16 v[68:71], v[184:187], v[156:159], v[68:71]
  buffer_load_dwordx4 v[148:151], v232, s[12:15], s36 offen
  s_waitcnt vmcnt(24)
  v_mfma_f32_16x16x32_bf16 v[8:11], v[168:171], v[160:163], v[8:11]
  v_mfma_f32_16x16x32_bf16 v[24:27], v[172:175], v[160:163], v[24:27]
  buffer_load_dwordx4 v[116:119], v224, s[8:11], s36 offen
  v_mfma_f32_16x16x32_bf16 v[40:43], v[176:179], v[160:163], v[40:43]
  v_mfma_f32_16x16x32_bf16 v[56:59], v[180:183], v[160:163], v[56:59]
  buffer_load_dwordx4 v[120:123], v225, s[8:11], s36 offen
  v_mfma_f32_16x16x32_bf16 v[72:75], v[184:187], v[160:163], v[72:75]
  s_waitcnt vmcnt(25)
  v_mfma_f32_16x16x32_bf16 v[12:15], v[168:171], v[164:167], v[12:15]
  buffer_load_dwordx4 v[124:127], v226, s[8:11], s36 offen
  v_mfma_f32_16x16x32_bf16 v[28:31], v[172:175], v[164:167], v[28:31]
  v_mfma_f32_16x16x32_bf16 v[44:47], v[176:179], v[164:167], v[44:47]
  buffer_load_dwordx4 v[128:131], v227, s[8:11], s36 offen
  s_add_u32 s36, s36, 1024
  v_mfma_f32_16x16x32_bf16 v[60:63], v[180:183], v[164:167], v[60:63]
  v_mfma_f32_16x16x32_bf16 v[76:79], v[184:187], v[164:167], v[76:79]
  s_waitcnt vmcnt(21)
  v_mfma_f32_16x16x32_bf16 v[0:3], v[204:207], v[188:191], v[0:3]
  v_mfma_f32_16x16x32_bf16 v[16:19], v[208:211], v[188:191], v[16:19]
  buffer_load_dwordx4 v[168:171], v228, s[12:15], s36 offen
  v_mfma_f32_16x16x32_bf16 v[32:35], v[212:215], v[188:191], v[32:35]
  v_mfma_f32_16x16x32_bf16 v[48:51], v[216:219], v[188:191], v[48:51]
  buffer_load_dwordx4 v[172:175], v229, s[12:15], s36 offen
  v_mfma_f32_16x16x32_bf16 v[64:67], v[220:223], v[188:191], v[64:67]
  s_waitcnt vmcnt(22)
  v_mfma_f32_16x16x32_bf16 v[4:7], v[204:207], v[192:195], v[4:7]
  buffer_load_dwordx4 v[176:179], v230, s[12:15], s36 offen
  v_mfma_f32_16x16x32_bf16 v[20:23], v[208:211], v[192:195], v[20:23]
  v_mfma_f32_16x16x32_bf16 v[36:39], v[212:215], v[192:195], v[36:39]
  buffer_load_dwordx4 v[180:183], v231, s[12:15], s36 offen
  v_mfma_f32_16x16x32_bf16 v[52:55], v[216:219], v[192:195], v[52:55]
  v_mfma_f32_16x16x32_bf16 v[68:71], v[220:223], v[192:195], v[68:71]
  buffer_load_dwordx4 v[184:187], v232, s[12:15], s36 offen
  s_waitcnt vmcnt(24)
  v_mfma_f32_16x16x32_bf16 v[8:11], v[204:207], v[196:199], v[8:11]
  v_mfma_f32_16x16x32_bf16 v[24:27], v[208:211], v[196:199], v[24:27]
  buffer_load_dwordx4 v[152:155], v224, s[8:11], s36 offen
  v_mfma_f32_16x16x32_bf16 v[40:43], v[212:215], v[196:199], v[40:43]
  v_mfma_f32_16x16x32_bf16 v[56:59], v[216:219], v[196:199], v[56:59]
  buffer_load_dwordx4 v[156:159], v225, s[8:11], s36 offen
  v_mfma_f32_16x16x32_bf16 v[72:75], v[220:223], v[196:199], v[72:75]
  s_waitcnt vmcnt(25)
  v_mfma_f32_16x16x32_bf16 v[12:15], v[204:207], v[200:203], v[12:15]
  buffer_load_dwordx4 v[160:163], v226, s[8:11], s36 offen
  v_mfma_f32_16x16x32_bf16 v[28:31], v[208:211], v[200:203], v[28:31]
  v_mfma_f32_16x16x32_bf16 v[44:47], v[212:215], v[200:203], v[44:47]
  buffer_load_dwordx4 v[164:167], v227, s[8:11], s36 offen
  s_add_u32 s36, s36, 1024
  v_mfma_f32_16x16x32_bf16 v[60:63], v[216:219], v[200:203], v[60:63]
  v_mfma_f32_16x16x32_bf16 v[76:79], v[220:223], v[200:203], v[76:79]
  s_waitcnt vmcnt(21)
  v_mfma_f32_16x16x32_bf16 v[0:3], v[96:99], v[80:83], v[0:3]
  v_mfma_f32_16x16x32_bf16 v[16:19], v[100:103], v[80:83], v[16:19]
  buffer_load_dwordx4 v[204:207], v228, s[12:15], s36 offen
  v_mfma_f32_16x16x32_bf16 v[32:35], v[104:107], v[80:83], v[32:35]
  v_mfma_f32_16x16x32_bf16 v[48:51], v[108:111], v[80:83], v[48:51]
  buffer_load_dwordx4 v[208:211], v229, s[12:15], s36 offen
  v_mfma_f32_16x16x32_bf16 v[64:67], v[112:115], v[80:83], v[64:67]
  s_waitcnt vmcnt(22)
  v_mfma_f32_16x16x32_bf16 v[4:7], v[96:99], v[84:87], v[4:7]
  buffer_load_dwordx4 v[212:215], v230, s[12:15], s36 offen
  v_mfma_f32_16x16x32_bf16 v[20:23], v[100:103], v[84:87], v[20:23]
  v_mfma_f32_16x16x32_bf16 v[36:39], v[104:107], v[84:87], v[36:39]
  buffer_load_dwordx4 v[216:219], v231, s[12:15], s36 offen
  v_mfma_f32_16x16x32_bf16 v[52:55], v[108:111], v[84:87], v[52:55]
  v_mfma_f32_16x16x32_bf16 v[68:71], v[112:115], v[84:87], v[68:71]
  buffer_load_dwordx4 v[220:223], v232, s[12:15], s36 offen
  s_waitcnt vmcnt(24)
  v_mfma_f32_16x16x32_bf16 v[8:11], v[96:99], v[88:91], v[8:11]
  v_mfma_f32_16x16x32_bf16 v[24:27], v[100:103], v[88:91], v[24:27]
  buffer_load_dwordx4 v[188:191], v224, s[8:11], s36 offen
  v_mfma_f32_16x16x32_bf16 v[40:43], v[104:107], v[88:91], v[40:43]
  v_mfma_f32_16x16x32_bf16 v[56:59], v[108:111], v[88:91], v[56:59]
  buffer_load_dwordx4 v[192:195], v225, s[8:11], s36 offen
  v_mfma_f32_16x16x32_bf16 v[72:75], v[112:115], v[88:91], v[72:75]
  s_waitcnt vmcnt(25)
  v_mfma_f32_16x16x32_bf16 v[12:15], v[96:99], v[92:95], v[12:15]
  buffer_load_dwordx4 v[196:199], v226, s[8:11], s36 offen
  v_mfma_f32_16x16x32_bf16 v[28:31], v[100:103], v[92:95], v[28:31]
  v_mfma_f32_16x16x32_bf16 v[44:47], v[104:107], v[92:95], v[44:47]
  buffer_load_dwordx4 v[200:203], v227, s[8:11], s36 offen
  s_add_u32 s36, s36, 1024
  v_mfma_f32_16x16x32_bf16 v[60:63], v[108:111], v[92:95], v[60:63]
  v_mfma_f32_16x16x32_bf16 v[76:79], v[112:115], v[92:95], v[76:79]
  s_waitcnt vmcnt(21)
  v_mfma_f32_16x16x32_bf16 v[0:3], v[132:135], v[116:119], v[0:3]
  v_mfma_f32_16x16x32_bf16 v[16:19], v[136:139], v[116:119], v[16:19]
  buffer_load_dwordx4 v[96:99], v228, s[12:15], s36 offen
  v_mfma_f32_16x16x32_bf16 v[32:35], v[140:143], v[116:119], v[32:35]
  v_mfma_f32_16x16x32_bf16 v[48:51], v[144:147], v[116:119], v[48:51]
  buffer_load_dwordx4 v[100:103], v229, s[12:15], s36 offen
  v_mfma_f32_16x16x32_bf16 v[64:67], v[148:151], v[116:119], v[64:67]
  s_waitcnt vmcnt(22)
  v_mfma_f32_16x16x32_bf16 v[4:7], v[132:135], v[120:123], v[4:7]
  buffer_load_dwordx4 v[104:107], v230, s[12:15], s36 offen
  v_mfma_f32_16x16x32_bf16 v[20:23], v[136:139], v[120:123], v[20:23]
  v_mfma_f32_16x16x32_bf16 v[36:39], v[140:143], v[120:123], v[36:39]
  buffer_load_dwordx4 v[108:111], v231, s[12:15], s36 offen
  v_mfma_f32_16x16x32_bf16 v[52:55], v[144:147], v[120:123], v[52:55]
  v_mfma_f32_16x16x32_bf16 v[68:71], v[148:151], v[120:123], v[68:71]
  buffer_load_dwordx4 v[112:115], v232, s[12:15], s36 offen
  s_waitcnt vmcnt(24)
  v_mfma_f32_16x16x32_bf16 v[8:11], v[132:135], v[124:127], v[8:11]
  v_mfma_f32_16x16x32_bf16 v[24:27], v[136:139], v[124:127], v[24:27]
  buffer_load_dwordx4 v[80:83], v224, s[8:11], s36 offen
  v_mfma_f32_16x16x32_bf16 v[40:43], v[140:143], v[124:127], v[40:43]
  v_mfma_f32_16x16x32_bf16 v[56:59], v[144:147], v[124:127], v[56:59]
  buffer_load_dwordx4 v[84:87], v225, s[8:11], s36 offen
  v_mfma_f32_16x16x32_bf16 v[72:75], v[148:151], v[124:127], v[72:75]
  s_waitcnt vmcnt(25)
  v_mfma_f32_16x16x32_bf16 v[12:15], v[132:135], v[128:131], v[12:15]
  buffer_load_dwordx4 v[88:91], v226, s[8:11], s36 offen
  v_mfma_f32_16x16x32_bf16 v[28:31], v[136:139], v[128:131], v[28:31]
  v_mfma_f32_16x16x32_bf16 v[44:47], v[140:143], v[128:131], v[44:47]
  buffer_load_dwordx4 v[92:95], v227, s[8:11], s36 offen
  s_add_u32 s36, s36, 1024
  v_mfma_f32_16x16x32_bf16 v[60:63], v[144:147], v[128:131], v[60:63]
  v_mfma_f32_16x16x32_bf16 v[76:79], v[148:151], v[128:131], v[76:79]
  s_waitcnt vmcnt(21)
  v_mfma_f32_16x16x32_bf16 v[0:3], v[168:171], v[152:155], v[0:3]
  v_mfma_f32_16x16x32_bf16 v[16:19], v[172:175], v[152:155], v[16:19]
  buffer_load_dwordx4 v[132:135], v228, s[12:15], s36 offen
  v_mfma_f32_16x16x32_bf16 v[32:35], v[176:179], v[152:155], v[32:35]
  v_mfma_f32_16x16x32_bf16 v[48:51], v[180:183], v[152:155], v[48:51]
  buffer_load_dwordx4 v[136:139], v229, s[12:15], s36 offen
  v_mfma_f32_16x16x32_bf16 v[64:67], v[184:187], v[152:155], v[64:67]
  s_waitcnt vmcnt(22)
  v_mfma_f32_16x16x32_bf16 v[4:7], v[168:171], v[156:159], v[4:7]
  buffer_load_dwordx4 v[140:143], v230, s[12:15], s36 offen
  v_mfma_f32_16x16x32_bf16 v[20:23], v[172:175], v[156:159], v[20:23]
  v_mfma_f32_16x16x32_bf16 v[36:39], v[176:179], v[156:159], v[36:39]
  buffer_load_dwordx4 v[144:147], v231, s[12:15], s36 offen
  v_mfma_f32_16x16x32_bf16 v[52:55], v[180:183], v[156:159], v[52:55]
  v_mfma_f32_16x16x32_bf16 v[68:71], v[184:187], v[156:159], v[68:71]
  buffer_load_dwordx4 v[148:151], v232, s[12:15], s36 offen
  s_waitcnt vmcnt(24)
  v_mfma_f32_16x16x32_bf16 v[8:11], v[168:171], v[160:163], v[8:11]
  v_mfma_f32_16x16x32_bf16 v[24:27], v[172:175], v[160:163], v[24:27]
  buffer_load_dwordx4 v[116:119], v224, s[8:11], s36 offen
  v_mfma_f32_16x16x32_bf16 v[40:43], v[176:179], v[160:163], v[40:43]
  v_mfma_f32_16x16x32_bf16 v[56:59], v[180:183], v[160:163], v[56:59]
  buffer_load_dwordx4 v[120:123], v225, s[8:11], s36 offen
  v_mfma_f32_16x16x32_bf16 v[72:75], v[184:187], v[160:163], v[72:75]
  s_waitcnt vmcnt(25)
  v_mfma_f32_16x16x32_bf16 v[12:15], v[168:171], v[164:167], v[12:15]
  buffer_load_dwordx4 v[124:127], v226, s[8:11], s36 offen
  v_mfma_f32_16x16x32_bf16 v[28:31], v[172:175], v[164:167], v[28:31]
  v_mfma_f32_16x16x32_bf16 v[44:47], v[176:179], v[164:167], v[44:47]
  buffer_load_dwordx4 v[128:131], v227, s[8:11], s36 offen
  s_add_u32 s36, s36, 1024
  v_mfma_f32_16x16x32_bf16 v[60:63], v[180:183], v[164:167], v[60:63]
  v_mfma_f32_16x16x32_bf16 v[76:79], v[184:187], v[164:167], v[76:79]
  s_waitcnt vmcnt(21)
  v_mfma_f32_16x16x32_bf16 v[0:3], v[204:207], v[188:191], v[0:3]
  v_mfma_f32_16x16x32_bf16 v[16:19], v[208:211], v[188:191], v[16:19]
  buffer_load_dwordx4 v[168:171], v228, s[12:15], s36 offen
  v_mfma_f32_16x16x32_bf16 v[32:35], v[212:215], v[188:191], v[32:35]
  v_mfma_f32_16x16x32_bf16 v[48:51], v[216:219], v[188:191], v[48:51]
  buffer_load_dwordx4 v[172:175], v229, s[12:15], s36 offen
  v_mfma_f32_16x16x32_bf16 v[64:67], v[220:223], v[188:191], v[64:67]
  s_waitcnt vmcnt(22)
  v_mfma_f32_16x16x32_bf16 v[4:7], v[204:207], v[192:195], v[4:7]
  buffer_load_dwordx4 v[176:179], v230, s[12:15], s36 offen
  v_mfma_f32_16x16x32_bf16 v[20:23], v[208:211], v[192:195], v[20:23]
  v_mfma_f32_16x16x32_bf16 v[36:39], v[212:215], v[192:195], v[36:39]
  buffer_load_dwordx4 v[180:183], v231, s[12:15], s36 offen
  v_mfma_f32_16x16x32_bf16 v[52:55], v[216:219], v[192:195], v[52:55]
  v_mfma_f32_16x16x32_bf16 v[68:71], v[220:223], v[192:195], v[68:71]
  buffer_load_dwordx4 v[184:187], v232, s[12:15], s36 offen
  s_waitcnt vmcnt(24)
  v_mfma_f32_16x16x32_bf16 v[8:11], v[204:207], v[196:199], v[8:11]
  v_mfma_f32_16x16x32_bf16 v[24:27], v[208:211], v[196:199], v[24:27]
  buffer_load_dwordx4 v[152:155], v224, s[8:11], s36 offen
  v_mfma_f32_16x16x32_bf16 v[40:43], v[212:215], v[196:199], v[40:43]
  v_mfma_f32_16x16x32_bf16 v[56:59], v[216:219], v[196:199], v[56:59]
  buffer_load_dwordx4 v[156:159], v225, s[8:11], s36 offen
  v_mfma_f32_16x16x32_bf16 v[72:75], v[220:223], v[196:199], v[72:75]
  s_waitcnt vmcnt(25)
  v_mfma_f32_16x16x32_bf16 v[12:15], v[204:207], v[200:203], v[12:15]
  buffer_load_dwordx4 v[160:163], v226, s[8:11], s36 offen
  v_mfma_f32_16x16x32_bf16 v[28:31], v[208:211], v[200:203], v[28:31]
  v_mfma_f32_16x16x32_bf16 v[44:47], v[212:215], v[200:203], v[44:47]
  buffer_load_dwordx4 v[164:167], v227, s[8:11], s36 offen
  s_add_u32 s36, s36, 1024
  v_mfma_f32_16x16x32_bf16 v[60:63], v[216:219], v[200:203], v[60:63]
  v_mfma_f32_16x16x32_bf16 v[76:79], v[220:223], v[200:203], v[76:79]
  s_waitcnt vmcnt(21)
  v_mfma_f32_16x16x32_bf16 v[0:3], v[96:99], v[80:83], v[0:3]
  v_mfma_f32_16x16x32_bf16 v[16:19], v[100:103], v[80:83], v[16:19]
  buffer_load_dwordx4 v[204:207], v228, s[12:15], s36 offen
  v_mfma_f32_16x16x32_bf16 v[32:35], v[104:107], v[80:83], v[32:35]
  v_mfma_f32_16x16x32_bf16 v[48:51], v[108:111], v[80:83], v[48:51]
  buffer_load_dwordx4 v[208:211], v229, s[12:15], s36 offen
  v_mfma_f32_16x16x32_bf16 v[64:67], v[112:115], v[80:83], v[64:67]
  s_waitcnt vmcnt(22)
  v_mfma_f32_16x16x32_bf16 v[4:7], v[96:99], v[84:87], v[4:7]
  buffer_load_dwordx4 v[212:215], v230, s[12:15], s36 offen
  v_mfma_f32_16x16x32_bf16 v[20:23], v[100:103], v[84:87], v[20:23]
  v_mfma_f32_16x16x32_bf16 v[36:39], v[104:107], v[84:87], v[36:39]
  buffer_load_dwordx4 v[216:219], v231, s[12:15], s36 offen
  v_mfma_f32_16x16x32_bf16 v[52:55], v[108:111], v[84:87], v[52:55]
  v_mfma_f32_16x16x32_bf16 v[68:71], v[112:115], v[84:87], v[68:71]
  buffer_load_dwordx4 v[220:223], v232, s[12:15], s36 offen
  s_waitcnt vmcnt(24)
  v_mfma_f32_16x16x32_bf16 v[8:11], v[96:99], v[88:91], v[8:11]
  v_mfma_f32_16x16x32_bf16 v[24:27], v[100:103], v[88:91], v[24:27]
  buffer_load_dwordx4 v[188:191], v224, s[8:11], s36 offen
  v_mfma_f32_16x16x32_bf16 v[40:43], v[104:107], v[88:91], v[40:43]
  v_mfma_f32_16x16x32_bf16 v[56:59], v[108:111], v[88:91], v[56:59]
  buffer_load_dwordx4 v[192:195], v225, s[8:11], s36 offen
  v_mfma_f32_16x16x32_bf16 v[72:75], v[112:115], v[88:91], v[72:75]
  s_waitcnt vmcnt(25)
  v_mfma_f32_16x16x32_bf16 v[12:15], v[96:99], v[92:95], v[12:15]
  buffer_load_dwordx4 v[196:199], v226, s[8:11], s36 offen
  v_mfma_f32_16x16x32_bf16 v[28:31], v[100:103], v[92:95], v[28:31]
  v_mfma_f32_16x16x32_bf16 v[44:47], v[104:107], v[92:95], v[44:47]
  buffer_load_dwordx4 v[200:203], v227, s[8:11], s36 offen
  s_add_u32 s36, s36, 1024
  v_mfma_f32_16x16x32_bf16 v[60:63], v[108:111], v[92:95], v[60:63]
  v_mfma_f32_16x16x32_bf16 v[76:79], v[112:115], v[92:95], v[76:79]
  s_waitcnt vmcnt(21)
  v_mfma_f32_16x16x32_bf16 v[0:3], v[132:135], v[116:119], v[0:3]
  v_mfma_f32_16x16x32_bf16 v[16:19], v[136:139], v[116:119], v[16:19]
  s_cmp_lt_u32 s36, 55296
  s_cselect_b32 s37, s36, 0x7fff0000
  buffer_load_dwordx4 v[96:99], v228, s[12:15], s37 offen
  v_mfma_f32_16x16x32_bf16 v[32:35], v[140:143], v[116:119], v[32:35]
  v_mfma_f32_16x16x32_bf16 v[48:51], v[144:147], v[116:119], v[48:51]
  buffer_load_dwordx4 v[100:103], v229, s[12:15], s37 offen
  v_mfma_f32_16x16x32_bf16 v[64:67], v[148:151], v[116:119], v[64:67]
  s_waitcnt vmcnt(22)
  v_mfma_f32_16x16x32_bf16 v[4:7], v[132:135], v[120:123], v[4:7]
  buffer_load_dwordx4 v[104:107], v230, s[12:15], s37 offen
  v_mfma_f32_16x16x32_bf16 v[20:23], v[136:139], v[120:123], v[20:23]
  v_mfma_f32_16x16x32_bf16 v[36:39], v[140:143], v[120:123], v[36:39]
  buffer_load_dwordx4 v[108:111], v231, s[12:15], s37 offen
  v_mfma_f32_16x16x32_bf16 v[52:55], v[144:147], v[120:123], v[52:55]
  v_mfma_f32_16x16x32_bf16 v[68:71], v[148:151], v[120:123], v[68:71]
  buffer_load_dwordx4 v[112:115], v232, s[12:15], s37 offen
  s_waitcnt vmcnt(24)
  v_mfma_f32_16x16x32_bf16 v[8:11], v[132:135], v[124:127], v[8:11]
  v_mfma_f32_16x16x32_bf16 v[24:27], v[136:139], v[124:127], v[24:27]
  buffer_load_dwordx4 v[80:83], v224, s[8:11], s37 offen
  v_mfma_f32_16x16x32_bf16 v[40:43], v[140:143], v[124:127], v[40:43]
  v_mfma_f32_16x16x32_bf16 v[56:59], v[144:147], v[124:127], v[56:59]
  buffer_load_dwordx4 v[84:87], v225, s[8:11], s37 offen
  v_mfma_f32_16x16x32_bf16 v[72:75], v[148:151], v[124:127], v[72:75]
  s_waitcnt vmcnt(25)
  v_mfma_f32_16x16x32_bf16 v[12:15], v[132:135], v[128:131], v[12:15]
  buffer_load_dwordx4 v[88:91], v226, s[8:11], s37 offen
  v_mfma_f32_16x16x32_bf16 v[28:31], v[136:139], v[128:131], v[28:31]
  v_mfma_f32_16x16x32_bf16 v[44:47], v[140:143], v[128:131], v[44:47]
  buffer_load_dwordx4 v[92:95], v227, s[8:11], s37 offen
  s_add_u32 s36, s36, 1024
  v_mfma_f32_16x16x32_bf16 v[60:63], v[144:147], v[128:131], v[60:63]
  v_mfma_f32_16x16x32_bf16 v[76:79], v[148:151], v[128:131], v[76:79]
  s_waitcnt vmcnt(21)
  v_mfma_f32_16x16x32_bf16 v[0:3], v[168:171], v[152:155], v[0:3]
  v_mfma_f32_16x16x32_bf16 v[16:19], v[172:175], v[152:155], v[16:19]
  s_cmp_lt_u32 s36, 55296
  s_cselect_b32 s37, s36, 0x7fff0000
  buffer_load_dwordx4 v[132:135], v228, s[12:15], s37 offen
  v_mfma_f32_16x16x32_bf16 v[32:35], v[176:179], v[152:155], v[32:35]
  v_mfma_f32_16x16x32_bf16 v[48:51], v[180:183], v[152:155], v[48:51]
  buffer_load_dwordx4 v[136:139], v229, s[12:15], s37 offen
  v_mfma_f32_16x16x32_bf16 v[64:67], v[184:187], v[152:155], v[64:67]
  s_waitcnt vmcnt(22)
  v_mfma_f32_16x16x32_bf16 v[4:7], v[168:171], v[156:159], v[4:7]
  buffer_load_dwordx4 v[140:143], v230, s[12:15], s37 offen
  v_mfma_f32_16x16x32_bf16 v[20:23], v[172:175], v[156:159], v[20:23]
  v_mfma_f32_16x16x32_bf16 v[36:39], v[176:179], v[156:159], v[36:39]
  buffer_load_dwordx4 v[144:147], v231, s[12:15], s37 offen
  v_mfma_f32_16x16x32_bf16 v[52:55], v[180:183], v[156:159], v[52:55]
  v_mfma_f32_16x16x32_bf16 v[68:71], v[184:187], v[156:159], v[68:71]
  buffer_load_dwordx4 v[148:151], v232, s[12:15], s37 offen
  s_waitcnt vmcnt(24)
  v_mfma_f32_16x16x32_bf16 v[8:11], v[168:171], v[160:163], v[8:11]
  v_mfma_f32_16x16x32_bf16 v[24:27], v[172:175], v[160:163], v[24:27]
  buffer_load_dwordx4 v[116:119], v224, s[8:11], s37 offen
  v_mfma_f32_16x16x32_bf16 v[40:43], v[176:179], v[160:163], v[40:43]
  v_mfma_f32_16x16x32_bf16 v[56:59], v[180:183], v[160:163], v[56:59]
  buffer_load_dwordx4 v[120:123], v225, s[8:11], s37 offen
  v_mfma_f32_16x16x32_bf16 v[72:75], v[184:187], v[160:163], v[72:75]
  s_waitcnt vmcnt(25)
  v_mfma_f32_16x16x32_bf16 v[12:15], v[168:171], v[164:167], v[12:15]
  buffer_load_dwordx4 v[124:127], v226, s[8:11], s37 offen
  v_mfma_f32_16x16x32_bf16 v[28:31], v[172:175], v[164:167], v[28:31]
  v_mfma_f32_16x16x32_bf16 v[44:47], v[176:179], v[164:167], v[44:47]
  buffer_load_dwordx4 v[128:131], v227, s[8:11], s37 offen
  s_add_u32 s36, s36, 1024
  v_mfma_f32_16x16x32_bf16 v[60:63], v[180:183], v[164:167], v[60:63]
  v_mfma_f32_16x16x32_bf16 v[76:79], v[184:187], v[164:167], v[76:79]
  s_waitcnt vmcnt(21)
  v_mfma_f32_16x16x32_bf16 v[0:3], v[204:207], v[188:191], v[0:3]
  v_mfma_f32_16x16x32_bf16 v[16:19], v[208:211], v[188:191], v[16:19]
  buffer_load_dwordx2 v[234:235], v244, s[20:23], s41 offen
  v_mfma_f32_16x16x32_bf16 v[32:35], v[212:215], v[188:191], v[32:35]
  v_mfma_f32_16x16x32_bf16 v[48:51], v[216:219], v[188:191], v[48:51]
  buffer_load_dwordx2 v[236:237], v245, s[20:23], s41 offen
  v_mfma_f32_16x16x32_bf16 v[64:67], v[220:223], v[188:191], v[64:67]
  s_waitcnt vmcnt(22)
  v_mfma_f32_16x16x32_bf16 v[4:7], v[204:207], v[192:195], v[4:7]
  buffer_load_dwordx2 v[238:239], v246, s[20:23], s41 offen
  v_mfma_f32_16x16x32_bf16 v[20:23], v[208:211], v[192:195], v[20:23]
  v_mfma_f32_16x16x32_bf16 v[36:39], v[212:215], v[192:195], v[36:39]
  buffer_load_dwordx2 v[240:241], v247, s[20:23], s41 offen
  v_mfma_f32_16x16x32_bf16 v[52:55], v[216:219], v[192:195], v[52:55]
  v_mfma_f32_16x16x32_bf16 v[68:71], v[220:223], v[192:195], v[68:71]
  buffer_load_dwordx2 v[242:243], v248, s[20:23], s41 offen
  s_waitcnt vmcnt(24)
  v_mfma_f32_16x16x32_bf16 v[8:11], v[204:207], v[196:199], v[8:11]
  v_mfma_f32_16x16x32_bf16 v[24:27], v[208:211], v[196:199], v[24:27]
  v_mfma_f32_16x16x32_bf16 v[40:43], v[212:215], v[196:199], v[40:43]
  v_mfma_f32_16x16x32_bf16 v[56:59], v[216:219], v[196:199], v[56:59]
  v_mfma_f32_16x16x32_bf16 v[72:75], v[220:223], v[196:199], v[72:75]
  s_waitcnt vmcnt(23)
  v_mfma_f32_16x16x32_bf16 v[12:15], v[204:207], v[200:203], v[12:15]
  v_mfma_f32_16x16x32_bf16 v[28:31], v[208:211], v[200:203], v[28:31]
  v_mfma_f32_16x16x32_bf16 v[44:47], v[212:215], v[200:203], v[44:47]
  v_mfma_f32_16x16x32_bf16 v[60:63], v[216:219], v[200:203], v[60:63]
  v_mfma_f32_16x16x32_bf16 v[76:79], v[220:223], v[200:203], v[76:79]
  s_waitcnt vmcnt(17)
  v_mfma_f32_16x16x32_bf16 v[0:3], v[96:99], v[80:83], v[0:3]
  v_mfma_f32_16x16x32_bf16 v[16:19], v[100:103], v[80:83], v[16:19]
  v_mfma_f32_16x16x32_bf16 v[32:35], v[104:107], v[80:83], v[32:35]
  v_mfma_f32_16x16x32_bf16 v[48:51], v[108:111], v[80:83], v[48:51]
  v_mfma_f32_16x16x32_bf16 v[64:67], v[112:115], v[80:83], v[64:67]
  s_waitcnt vmcnt(16)
  v_mfma_f32_16x16x32_bf16 v[4:7], v[96:99], v[84:87], v[4:7]
  v_mfma_f32_16x16x32_bf16 v[20:23], v[100:103], v[84:87], v[20:23]
  v_mfma_f32_16x16x32_bf16 v[36:39], v[104:107], v[84:87], v[36:39]
  v_mfma_f32_16x16x32_bf16 v[52:55], v[108:111], v[84:87], v[52:55]
  v_mfma_f32_16x16x32_bf16 v[68:71], v[112:115], v[84:87], v[68:71]
  s_waitcnt vmcnt(15)
  v_mfma_f32_16x16x32_bf16 v[8:11], v[96:99], v[88:91], v[8:11]
  v_mfma_f32_16x16x32_bf16 v[24:27], v[100:103], v[88:91], v[24:27]
  v_mfma_f32_16x16x32_bf16 v[40:43], v[104:107], v[88:91], v[40:43]
  v_mfma_f32_16x16x32_bf16 v[56:59], v[108:111], v[88:91], v[56:59]
  v_mfma_f32_16x16x32_bf16 v[72:75], v[112:115], v[88:91], v[72:75]
  s_waitcnt vmcnt(14)
  v_mfma_f32_16x16x32_bf16 v[12:15], v[96:99], v[92:95], v[12:15]
  v_mfma_f32_16x16x32_bf16 v[28:31], v[100:103], v[92:95], v[28:31]
  v_mfma_f32_16x16x32_bf16 v[44:47], v[104:107], v[92:95], v[44:47]
  v_mfma_f32_16x16x32_bf16 v[60:63], v[108:111], v[92:95], v[60:63]
  v_mfma_f32_16x16x32_bf16 v[76:79], v[112:115], v[92:95], v[76:79]
  s_waitcnt vmcnt(8)
  v_mfma_f32_16x16x32_bf16 v[0:3], v[132:135], v[116:119], v[0:3]
  v_mfma_f32_16x16x32_bf16 v[16:19], v[136:139], v[116:119], v[16:19]
  v_mfma_f32_16x16x32_bf16 v[32:35], v[140:143], v[116:119], v[32:35]
  v_mfma_f32_16x16x32_bf16 v[48:51], v[144:147], v[116:119], v[48:51]
  v_mfma_f32_16x16x32_bf16 v[64:67], v[148:151], v[116:119], v[64:67]
  s_waitcnt vmcnt(7)
  v_mfma_f32_16x16x32_bf16 v[4:7], v[132:135], v[120:123], v[4:7]
  v_mfma_f32_16x16x32_bf16 v[20:23], v[136:139], v[120:123], v[20:23]
  v_mfma_f32_16x16x32_bf16 v[36:39], v[140:143], v[120:123], v[36:39]
  v_mfma_f32_16x16x32_bf16 v[52:55], v[144:147], v[120:123], v[52:55]
  v_mfma_f32_16x16x32_bf16 v[68:71], v[148:151], v[120:123], v[68:71]
  s_waitcnt vmcnt(6)
  v_mfma_f32_16x16x32_bf16 v[8:11], v[132:135], v[124:127], v[8:11]
  v_mfma_f32_16x16x32_bf16 v[24:27], v[136:139], v[124:127], v[24:27]
  v_mfma_f32_16x16x32_bf16 v[40:43], v[140:143], v[124:127], v[40:43]
  v_mfma_f32_16x16x32_bf16 v[56:59], v[144:147], v[124:127], v[56:59]
  v_mfma_f32_16x16x32_bf16 v[72:75], v[148:151], v[124:127], v[72:75]
  s_waitcnt vmcnt(5)
  v_mfma_f32_16x16x32_bf16 v[12:15], v[132:135], v[128:131], v[12:15]
  v_mfma_f32_16x16x32_bf16 v[28:31], v[136:139], v[128:131], v[28:31]
  v_mfma_f32_16x16x32_bf16 v[44:47], v[140:143], v[128:131], v[44:47]
  v_mfma_f32_16x16x32_bf16 v[60:63], v[144:147], v[128:131], v[60:63]
  v_mfma_f32_16x16x32_bf16 v[76:79], v[148:151], v[128:131], v[76:79]
  s_add_u32 s43, s53, 1
  s_and_b32 s43, s43, 3
  s_mul_i32 s48, s43, 15360
  s_add_u32 s48, s48, 12288
  v_add_u32 v81, s48, v252
  s_add_u32 s43, s53, 2
  s_and_b32 s43, s43, 3
  s_mul_i32 s48, s43, 15360
  s_add_u32 s48, s48, 17408
  v_add_u32 v82, s48, v252
  s_add_u32 s43, s53, 3
  s_and_b32 s43, s43, 3
  s_mul_i32 s48, s43, 15360
  s_add_u32 s48, s48, 22528
  v_add_u32 v83, s48, v252
  s_mul_i32 s48, s53, 15360
  s_add_u32 s48, s48, 12288
  v_add_u32 v84, s48, v252
  ds_write_b128 v81, v[4:7] offset:0
  ds_write_b128 v81, v[20:23] offset:1024
  ds_write_b128 v81, v[36:39] offset:2048
  ds_write_b128 v81, v[52:55] offset:3072
  ds_write_b128 v81, v[68:71] offset:4096
  ds_write_b128 v82, v[8:11] offset:0
  ds_write_b128 v82, v[24:27] offset:1024
  ds_write_b128 v82, v[40:43] offset:2048
  ds_write_b128 v82, v[56:59] offset:3072
  ds_write_b128 v82, v[72:75] offset:4096
  ds_write_b128 v83, v[12:15] offset:0
  ds_write_b128 v83, v[28:31] offset:1024
  ds_write_b128 v83, v[44:47] offset:2048
  ds_write_b128 v83, v[60:63] offset:3072
  ds_write_b128 v83, v[76:79] offset:4096
  v_and_b32 v253, 15, v250
  v_lshrrev_b32 v254, 4, v250
  v_lshrrev_b32 v85, 2, v253
  v_lshl_add_u32 v85, v254, 2, v85
  v_lshlrev_b32 v85, 5, v85
  v_and_b32 v255, 3, v253
  v_lshl_add_u32 v85, v255, 3, v85
  v_add_u32 v85, s39, v85
  v_mul_u32_u24 v86, 168, v253
  v_lshl_add_u32 v86, v254, 3, v86
  v_add_u32 v86, s48, v86
  v_add_u32 v253, 0, v250
  v_mul_u32_u24 v254, s40, v253
  v_lshrrev_b32 v254, 16, v254
  v_lshlrev_b32 v253, 3, v253
  v_lshl_add_u32 v253, v254, 3, v253
  v_add_u32 v108, s48, v253
  v_add_u32 v253, 64, v250
  v_mul_u32_u24 v254, s40, v253
  v_lshrrev_b32 v254, 16, v254
  v_lshlrev_b32 v253, 3, v253
  v_lshl_add_u32 v253, v254, 3, v253
  v_add_u32 v109, s48, v253
  v_add_u32 v253, 128, v250
  v_mul_u32_u24 v254, s40, v253
  v_lshrrev_b32 v254, 16, v254
  v_lshlrev_b32 v253, 3, v253
  v_lshl_add_u32 v253, v254, 3, v253
  v_add_u32 v110, s48, v253
  v_add_u32 v253, 192, v250
  v_mul_u32_u24 v254, s40, v253
  v_lshrrev_b32 v254, 16, v254
  v_lshlrev_b32 v253, 3, v253
  v_lshl_add_u32 v253, v254, 3, v253
  v_add_u32 v111, s48, v253
  v_add_u32 v253, 256, v250
  v_mul_u32_u24 v254, s40, v253
  v_lshrrev_b32 v254, 16, v254
  v_lshlrev_b32 v253, 3, v253
  v_lshl_add_u32 v253, v254, 3, v253
  v_add_u32 v112, s48, v253
  s_waitcnt vmcnt(0)
  v_lshlrev_b32 v180, 16, v234
  v_and_b32 v181, 0xffff0000, v234
  v_lshlrev_b32 v182, 16, v235
  v_and_b32 v183, 0xffff0000, v235
  v_lshlrev_b32 v184, 16, v236
  v_and_b32 v185, 0xffff0000, v236
  v_lshlrev_b32 v186, 16, v237
  v_and_b32 v187, 0xffff0000, v237
  v_lshlrev_b32 v188, 16, v238
  v_and_b32 v189, 0xffff0000, v238
  v_lshlrev_b32 v190, 16, v239
  v_and_b32 v191, 0xffff0000, v239
  v_lshlrev_b32 v192, 16, v240
  v_and_b32 v193, 0xffff0000, v240
  v_lshlrev_b32 v194, 16, v241
  v_and_b32 v195, 0xffff0000, v241
  v_lshlrev_b32 v196, 16, v242
  v_and_b32 v197, 0xffff0000, v242
  v_lshlrev_b32 v198, 16, v243
  v_and_b32 v199, 0xffff0000, v243
  s_waitcnt lgkmcnt(0)
  s_barrier
  s_add_u32 m0, s39, 0
  s_nop 0
  buffer_load_dwordx4 v249, s[16:19], s38 offen sc1 lds
  s_add_u32 m0, s39, 1024
  s_nop 0
  buffer_load_dwordx4 v249, s[16:19], s56 offen sc1 lds
  s_mov_b64 exec, 0xffffffff
  s_add_u32 m0, s39, 2048
  s_nop 0
  buffer_load_dwordx4 v249, s[16:19], s57 offen sc1 lds
  s_mov_b64 exec, -1
  ds_read_b128 v[116:119], v84 offset:0
  ds_read_b128 v[120:123], v84 offset:1024
  ds_read_b128 v[124:127], v84 offset:2048
  ds_read_b128 v[128:131], v84 offset:3072
  ds_read_b128 v[132:135], v84 offset:4096
  ds_read_b128 v[136:139], v84 offset:5120
  ds_read_b128 v[140:143], v84 offset:6144
  ds_read_b128 v[144:147], v84 offset:7168
  ds_read_b128 v[148:151], v84 offset:8192
  ds_read_b128 v[152:155], v84 offset:9216
  ds_read_b128 v[156:159], v84 offset:10240
  ds_read_b128 v[160:163], v84 offset:11264
  ds_read_b128 v[164:167], v84 offset:12288
  ds_read_b128 v[168:171], v84 offset:13312
  ds_read_b128 v[172:175], v84 offset:14336
  s_waitcnt lgkmcnt(10)
  v_add_f32 v88, v0, v116
  v_add_f32 v89, v1, v117
  v_add_f32 v90, v2, v118
  v_add_f32 v91, v3, v119
  v_add_f32 v92, v16, v120
  v_add_f32 v93, v17, v121
  v_add_f32 v94, v18, v122
  v_add_f32 v95, v19, v123
  v_add_f32 v96, v32, v124
  v_add_f32 v97, v33, v125
  v_add_f32 v98, v34, v126
  v_add_f32 v99, v35, v127
  v_add_f32 v100, v48, v128
  v_add_f32 v101, v49, v129
  v_add_f32 v102, v50, v130
  v_add_f32 v103, v51, v131
  v_add_f32 v104, v64, v132
  v_add_f32 v105, v65, v133
  v_add_f32 v106, v66, v134
  v_add_f32 v107, v67, v135
  s_waitcnt lgkmcnt(5)
  v_add_f32 v88, v88, v136
  v_add_f32 v89, v89, v137
  v_add_f32 v90, v90, v138
  v_add_f32 v91, v91, v139
  v_add_f32 v92, v92, v140
  v_add_f32 v93, v93, v141
  v_add_f32 v94, v94, v142
  v_add_f32 v95, v95, v143
  v_add_f32 v96, v96, v144
  v_add_f32 v97, v97, v145
  v_add_f32 v98, v98, v146
  v_add_f32 v99, v99, v147
  v_add_f32 v100, v100, v148
  v_add_f32 v101, v101, v149
  v_add_f32 v102, v102, v150
  v_add_f32 v103, v103, v151
  v_add_f32 v104, v104, v152
  v_add_f32 v105, v105, v153
  v_add_f32 v106, v106, v154
  v_add_f32 v107, v107, v155
  s_waitcnt lgkmcnt(0)
  v_add_f32 v88, v88, v156
  v_add_f32 v89, v89, v157
  v_add_f32 v90, v90, v158
  v_add_f32 v91, v91, v159
  v_add_f32 v92, v92, v160
  v_add_f32 v93, v93, v161
  v_add_f32 v94, v94, v162
  v_add_f32 v95, v95, v163
  v_add_f32 v96, v96, v164
  v_add_f32 v97, v97, v165
  v_add_f32 v98, v98, v166
  v_add_f32 v99, v99, v167
  v_add_f32 v100, v100, v168
  v_add_f32 v101, v101, v169
  v_add_f32 v102, v102, v170
  v_add_f32 v103, v103, v171
  v_add_f32 v104, v104, v172
  v_add_f32 v105, v105, v173
  v_add_f32 v106, v106, v174
  v_add_f32 v107, v107, v175
  v_cvt_pk_bf16_f32 v0, v88, v89
  v_cvt_pk_bf16_f32 v1, v90, v91
  v_cvt_pk_bf16_f32 v2, v92, v93
  v_cvt_pk_bf16_f32 v3, v94, v95
  v_cvt_pk_bf16_f32 v4, v96, v97
  v_cvt_pk_bf16_f32 v5, v98, v99
  v_cvt_pk_bf16_f32 v6, v100, v101
  v_cvt_pk_bf16_f32 v7, v102, v103
  v_cvt_pk_bf16_f32 v8, v104, v105
  v_cvt_pk_bf16_f32 v9, v106, v107
  v_lshlrev_b32 v88, 16, v0
  v_and_b32 v89, 0xffff0000, v0
  v_lshlrev_b32 v90, 16, v1
  v_and_b32 v91, 0xffff0000, v1
  v_lshlrev_b32 v92, 16, v2
  v_and_b32 v93, 0xffff0000, v2
  v_lshlrev_b32 v94, 16, v3
  v_and_b32 v95, 0xffff0000, v3
  v_lshlrev_b32 v96, 16, v4
  v_and_b32 v97, 0xffff0000, v4
  v_lshlrev_b32 v98, 16, v5
  v_and_b32 v99, 0xffff0000, v5
  v_lshlrev_b32 v100, 16, v6
  v_and_b32 v101, 0xffff0000, v6
  v_lshlrev_b32 v102, 16, v7
  v_and_b32 v103, 0xffff0000, v7
  v_lshlrev_b32 v104, 16, v8
  v_and_b32 v105, 0xffff0000, v8
  v_lshlrev_b32 v106, 16, v9
  v_and_b32 v107, 0xffff0000, v9
  v_mul_f32 v16, 0xbfb8aa3b, v88
  v_mul_f32 v17, 0xbfb8aa3b, v89
  v_mul_f32 v18, 0xbfb8aa3b, v90
  v_mul_f32 v19, 0xbfb8aa3b, v91
  v_mul_f32 v20, 0xbfb8aa3b, v92
  v_mul_f32 v21, 0xbfb8aa3b, v93
  v_mul_f32 v22, 0xbfb8aa3b, v94
  v_mul_f32 v23, 0xbfb8aa3b, v95
  v_mul_f32 v24, 0xbfb8aa3b, v96
  v_mul_f32 v25, 0xbfb8aa3b, v97
  v_mul_f32 v26, 0xbfb8aa3b, v98
  v_mul_f32 v27, 0xbfb8aa3b, v99
  v_mul_f32 v28, 0xbfb8aa3b, v100
  v_mul_f32 v29, 0xbfb8aa3b, v101
  v_mul_f32 v30, 0xbfb8aa3b, v102
  v_mul_f32 v31, 0xbfb8aa3b, v103
  v_mul_f32 v32, 0xbfb8aa3b, v104
  v_mul_f32 v33, 0xbfb8aa3b, v105
  v_mul_f32 v34, 0xbfb8aa3b, v106
  v_mul_f32 v35, 0xbfb8aa3b, v107
  v_exp_f32 v16, v16
  v_exp_f32 v17, v17
  v_exp_f32 v18, v18
  v_exp_f32 v19, v19
  v_exp_f32 v20, v20
  v_exp_f32 v21, v21
  v_exp_f32 v22, v22
  v_exp_f32 v23, v23
  v_exp_f32 v24, v24
  v_exp_f32 v25, v25
  v_exp_f32 v26, v26
  v_exp_f32 v27, v27
  v_exp_f32 v28, v28
  v_exp_f32 v29, v29
  v_exp_f32 v30, v30
  v_exp_f32 v31, v31
  v_exp_f32 v32, v32
  v_exp_f32 v33, v33
  v_exp_f32 v34, v34
  v_exp_f32 v35, v35
  v_add_f32 v16, 1.0, v16
  v_add_f32 v17, 1.0, v17
  v_add_f32 v18, 1.0, v18
  v_add_f32 v19, 1.0, v19
  v_add_f32 v20, 1.0, v20
  v_add_f32 v21, 1.0, v21
  v_add_f32 v22, 1.0, v22
  v_add_f32 v23, 1.0, v23
  v_add_f32 v24, 1.0, v24
  v_add_f32 v25, 1.0, v25
  v_add_f32 v26, 1.0, v26
  v_add_f32 v27, 1.0, v27
  v_add_f32 v28, 1.0, v28
  v_add_f32 v29, 1.0, v29
  v_add_f32 v30, 1.0, v30
  v_add_f32 v31, 1.0, v31
  v_add_f32 v32, 1.0, v32
  v_add_f32 v33, 1.0, v33
  v_add_f32 v34, 1.0, v34
  v_add_f32 v35, 1.0, v35
  v_rcp_f32 v16, v16
  v_rcp_f32 v17, v17
  v_rcp_f32 v18, v18
  v_rcp_f32 v19, v19
  v_rcp_f32 v20, v20
  v_rcp_f32 v21, v21
  v_rcp_f32 v22, v22
  v_rcp_f32 v23, v23
  v_rcp_f32 v24, v24
  v_rcp_f32 v25, v25
  v_rcp_f32 v26, v26
  v_rcp_f32 v27, v27
  v_rcp_f32 v28, v28
  v_rcp_f32 v29, v29
  v_rcp_f32 v30, v30
  v_rcp_f32 v31, v31
  v_rcp_f32 v32, v32
  v_rcp_f32 v33, v33
  v_rcp_f32 v34, v34
  v_rcp_f32 v35, v35
  v_mul_f32 v88, v88, v16
  v_mul_f32 v89, v89, v17
  v_mul_f32 v90, v90, v18
  v_mul_f32 v91, v91, v19
  v_mul_f32 v92, v92, v20
  v_mul_f32 v93, v93, v21
  v_mul_f32 v94, v94, v22
  v_mul_f32 v95, v95, v23
  v_mul_f32 v96, v96, v24
  v_mul_f32 v97, v97, v25
  v_mul_f32 v98, v98, v26
  v_mul_f32 v99, v99, v27
  v_mul_f32 v100, v100, v28
  v_mul_f32 v101, v101, v29
  v_mul_f32 v102, v102, v30
  v_mul_f32 v103, v103, v31
  v_mul_f32 v104, v104, v32
  v_mul_f32 v105, v105, v33
  v_mul_f32 v106, v106, v34
  v_mul_f32 v107, v107, v35
  v_cvt_pk_bf16_f32 v0, v88, v89
  v_cvt_pk_bf16_f32 v1, v90, v91
  v_cvt_pk_bf16_f32 v2, v92, v93
  v_cvt_pk_bf16_f32 v3, v94, v95
  v_cvt_pk_bf16_f32 v4, v96, v97
  v_cvt_pk_bf16_f32 v5, v98, v99
  v_cvt_pk_bf16_f32 v6, v100, v101
  v_cvt_pk_bf16_f32 v7, v102, v103
  v_cvt_pk_bf16_f32 v8, v104, v105
  v_cvt_pk_bf16_f32 v9, v106, v107
  v_lshlrev_b32 v88, 16, v0
  v_and_b32 v89, 0xffff0000, v0
  v_lshlrev_b32 v90, 16, v1
  v_and_b32 v91, 0xffff0000, v1
  v_lshlrev_b32 v92, 16, v2
  v_and_b32 v93, 0xffff0000, v2
  v_lshlrev_b32 v94, 16, v3
  v_and_b32 v95, 0xffff0000, v3
  v_lshlrev_b32 v96, 16, v4
  v_and_b32 v97, 0xffff0000, v4
  v_lshlrev_b32 v98, 16, v5
  v_and_b32 v99, 0xffff0000, v5
  v_lshlrev_b32 v100, 16, v6
  v_and_b32 v101, 0xffff0000, v6
  v_lshlrev_b32 v102, 16, v7
  v_and_b32 v103, 0xffff0000, v7
  v_lshlrev_b32 v104, 16, v8
  v_and_b32 v105, 0xffff0000, v8
  v_lshlrev_b32 v106, 16, v9
  v_and_b32 v107, 0xffff0000, v9
  s_mov_b32 s54, 0
  s_branch g2_chk
g2_poll:
  s_add_u32 m0, s39, 0
  s_nop 0
  buffer_load_dwordx4 v249, s[16:19], s38 offen sc1 lds
  s_add_u32 m0, s39, 1024
  s_nop 0
  buffer_load_dwordx4 v249, s[16:19], s56 offen sc1 lds
  s_mov_b64 exec, 0xffffffff
  s_add_u32 m0, s39, 2048
  s_nop 0
  buffer_load_dwordx4 v249, s[16:19], s57 offen sc1 lds
  s_mov_b64 exec, -1
g2_chk:
  s_waitcnt vmcnt(0)
  ds_read_b64_tr_b16 v[64:65], v85 offset:0
  ds_read_b64_tr_b16 v[66:67], v85 offset:512
  ds_read_b64_tr_b16 v[68:69], v85 offset:1024
  ds_read_b64_tr_b16 v[70:71], v85 offset:1536
  ds_read_b64_tr_b16 v[72:73], v85 offset:2048
  s_waitcnt lgkmcnt(0)
  v_pk_max_u16 v60, v64, v65
  v_pk_max_u16 v60, v60, v66
  v_pk_max_u16 v60, v60, v67
  v_pk_max_u16 v60, v60, v68
  v_pk_max_u16 v60, v60, v69
  v_pk_max_u16 v60, v60, v70
  v_pk_max_u16 v60, v60, v71
  v_pk_max_u16 v60, v60, v72
  v_pk_max_u16 v60, v60, v73
  v_lshrrev_b32 v61, 16, v60
  v_and_b32 v60, 0xffff, v60
  v_max_u32 v60, v60, v61
  v_cmp_eq_u32 vcc, 0xffff, v60
  s_add_u32 s54, s54, 1
  s_nop 3
  s_cbranch_vccz g2_ready
  s_sleep 6
  s_cmp_lt_u32 s54, 0x100000
  s_cbranch_scc1 g2_poll
g2_ready:
  v_lshlrev_b32 v40, 16, v64
  v_and_b32 v41, 0xffff0000, v64
  v_mul_f32 v88, v88, v40
  v_mul_f32 v89, v89, v41
  v_lshlrev_b32 v42, 16, v65
  v_and_b32 v43, 0xffff0000, v65
  v_mul_f32 v90, v90, v42
  v_mul_f32 v91, v91, v43
  v_lshlrev_b32 v44, 16, v66
  v_and_b32 v45, 0xffff0000, v66
  v_mul_f32 v92, v92, v44
  v_mul_f32 v93, v93, v45
  v_lshlrev_b32 v46, 16, v67
  v_and_b32 v47, 0xffff0000, v67
  v_mul_f32 v94, v94, v46
  v_mul_f32 v95, v95, v47
  v_lshlrev_b32 v48, 16, v68
  v_and_b32 v49, 0xffff0000, v68
  v_mul_f32 v96, v96, v48
  v_mul_f32 v97, v97, v49
  v_lshlrev_b32 v50, 16, v69
  v_and_b32 v51, 0xffff0000, v69
  v_mul_f32 v98, v98, v50
  v_mul_f32 v99, v99, v51
  v_lshlrev_b32 v52, 16, v70
  v_and_b32 v53, 0xffff0000, v70
  v_mul_f32 v100, v100, v52
  v_mul_f32 v101, v101, v53
  v_lshlrev_b32 v54, 16, v71
  v_and_b32 v55, 0xffff0000, v71
  v_mul_f32 v102, v102, v54
  v_mul_f32 v103, v103, v55
  v_lshlrev_b32 v56, 16, v72
  v_and_b32 v57, 0xffff0000, v72
  v_mul_f32 v104, v104, v56
  v_mul_f32 v105, v105, v57
  v_lshlrev_b32 v58, 16, v73
  v_and_b32 v59, 0xffff0000, v73
  v_mul_f32 v106, v106, v58
  v_mul_f32 v107, v107, v59
  v_cvt_pk_bf16_f32 v0, v88, v89
  v_cvt_pk_bf16_f32 v1, v90, v91
  ds_write_b64 v86, v[0:1] offset:0
  v_cvt_pk_bf16_f32 v2, v92, v93
  v_cvt_pk_bf16_f32 v3, v94, v95
  ds_write_b64 v86, v[2:3] offset:32
  v_cvt_pk_bf16_f32 v4, v96, v97
  v_cvt_pk_bf16_f32 v5, v98, v99
  ds_write_b64 v86, v[4:5] offset:64
  v_cvt_pk_bf16_f32 v6, v100, v101
  v_cvt_pk_bf16_f32 v7, v102, v103
  ds_write_b64 v86, v[6:7] offset:96
  v_cvt_pk_bf16_f32 v8, v104, v105
  v_cvt_pk_bf16_f32 v9, v106, v107
  ds_write_b64 v86, v[8:9] offset:128
  ds_read_b64 v[16:17], v108
  ds_read_b64 v[18:19], v109
  ds_read_b64 v[20:21], v110
  ds_read_b64 v[22:23], v111
  ds_read_b64 v[24:25], v112
  s_waitcnt lgkmcnt(4)
  v_lshlrev_b32 v88, 16, v16
  v_and_b32 v89, 0xffff0000, v16
  v_add_f32 v88, v88, v180
  v_add_f32 v89, v89, v181
  v_cvt_pk_bf16_f32 v234, v88, v89
  v_lshlrev_b32 v90, 16, v17
  v_and_b32 v91, 0xffff0000, v17
  v_add_f32 v90, v90, v182
  v_add_f32 v91, v91, v183
  v_cvt_pk_bf16_f32 v235, v90, v91
  buffer_store_dwordx2 v[234:235], v244, s[24:27], s41 offen
  s_waitcnt lgkmcnt(3)
  v_lshlrev_b32 v92, 16, v18
  v_and_b32 v93, 0xffff0000, v18
  v_add_f32 v92, v92, v184
  v_add_f32 v93, v93, v185
  v_cvt_pk_bf16_f32 v236, v92, v93
  v_lshlrev_b32 v94, 16, v19
  v_and_b32 v95, 0xffff0000, v19
  v_add_f32 v94, v94, v186
  v_add_f32 v95, v95, v187
  v_cvt_pk_bf16_f32 v237, v94, v95
  buffer_store_dwordx2 v[236:237], v245, s[24:27], s41 offen
  s_waitcnt lgkmcnt(2)
  v_lshlrev_b32 v96, 16, v20
  v_and_b32 v97, 0xffff0000, v20
  v_add_f32 v96, v96, v188
  v_add_f32 v97, v97, v189
  v_cvt_pk_bf16_f32 v238, v96, v97
  v_lshlrev_b32 v98, 16, v21
  v_and_b32 v99, 0xffff0000, v21
  v_add_f32 v98, v98, v190
  v_add_f32 v99, v99, v191
  v_cvt_pk_bf16_f32 v239, v98, v99
  buffer_store_dwordx2 v[238:239], v246, s[24:27], s41 offen
  s_waitcnt lgkmcnt(1)
  v_lshlrev_b32 v100, 16, v22
  v_and_b32 v101, 0xffff0000, v22
  v_add_f32 v100, v100, v192
  v_add_f32 v101, v101, v193
  v_cvt_pk_bf16_f32 v240, v100, v101
  v_lshlrev_b32 v102, 16, v23
  v_and_b32 v103, 0xffff0000, v23
  v_add_f32 v102, v102, v194
  v_add_f32 v103, v103, v195
  v_cvt_pk_bf16_f32 v241, v102, v103
  buffer_store_dwordx2 v[240:241], v247, s[24:27], s41 offen
  s_waitcnt lgkmcnt(0)
  v_lshlrev_b32 v104, 16, v24
  v_and_b32 v105, 0xffff0000, v24
  v_add_f32 v104, v104, v196
  v_add_f32 v105, v105, v197
  v_cvt_pk_bf16_f32 v242, v104, v105
  v_lshlrev_b32 v106, 16, v25
  v_and_b32 v107, 0xffff0000, v25
  v_add_f32 v106, v106, v198
  v_add_f32 v107, v107, v199
  v_cvt_pk_bf16_f32 v243, v106, v107
  buffer_store_dwordx2 v[242:243], v248, s[24:27], s41 offen
  s_endpgm
.section .rodata,"a"
.p2align 6
.amdhsa_kernel k1_kernel
  .amdhsa_next_free_vgpr 128
  .amdhsa_next_free_sgpr 102
  .amdhsa_accum_offset 128
  .amdhsa_group_segment_fixed_size 0
  .amdhsa_kernarg_size 128
  .amdhsa_user_sgpr_count 2
  .amdhsa_user_sgpr_kernarg_segment_ptr 1
  .amdhsa_system_sgpr_workgroup_id_x 1
  .amdhsa_ieee_mode 0
.end_amdhsa_kernel
.p2align 6
.amdhsa_kernel k2_kernel
  .amdhsa_next_free_vgpr 256
  .amdhsa_next_free_sgpr 102
  .amdhsa_accum_offset 256
  .amdhsa_group_segment_fixed_size 0
  .amdhsa_kernarg_size 128
  .amdhsa_user_sgpr_count 2
  .amdhsa_user_sgpr_kernarg_segment_ptr 1
  .amdhsa_system_sgpr_workgroup_id_x 1
  .amdhsa_ieee_mode 0
.end_amdhsa_kernel
```
